```python
import torch

def _softmax(x, axis=-1):
    return torch.softmax(x, dim=axis)
def _gelu(x):
    return torch.nn.functional.gelu(x, approximate="tanh")
def _silu(x):
    return torch.nn.functional.silu(x)
def _sigmoid(x):
    return torch.sigmoid(x)
def _layernorm(x, axis=-1, eps=1e-5):
    m = x.mean(dim=axis, keepdim=True)
    v = x.var(dim=axis, keepdim=True, unbiased=False)
    return (x - m) / torch.sqrt(v + eps)
def _scatter_add(tgt, idx, src, axis=0):
    return tgt.clone().index_add_(axis, idx, src)
def _segment_sum(src, seg, n):
    out = torch.zeros((n,) + src.shape[1:], dtype=src.dtype)
    return out.index_add_(0, seg, src)
def _pad(x, pw):
    flat = tuple(v for pair in reversed(pw) for v in pair)
    return torch.nn.functional.pad(x, flat)

kernel_name = 'gated_mix__sliding_block_cached__glu_gated_geglu__decode'

def setup_inputs():

    _w = (lambda a: (lambda t: t.to(torch.bfloat16) if t.is_floating_point() else t)(torch.as_tensor(a)))
    def _A_setup():
        B, Sq, D = 4, 1, 640
        Hq, Hkv, Sk, Dh = 32, 32, 4096, 128
        assert Hq % Hkv == 0, (Hq, Hkv)
        return {
            "x": _w((lambda *s: torch.randn(*s, dtype=torch.bfloat16) * 0.05)(B, Sq, D)),
            "k_cache": _w((lambda *s: torch.randn(*s, dtype=torch.bfloat16) * 6.4)(B, Hkv, Sk, Dh)),
            "v_cache": _w((lambda *s: torch.randn(*s, dtype=torch.bfloat16) * 0.05)(B, Hkv, Sk, Dh)),
            "wq": _w((lambda *s: torch.randn(*s, dtype=torch.bfloat16) * 6.4)(D, Hq * Dh) * (D ** -0.5)),
            "wo": _w((lambda *s: torch.randn(*s, dtype=torch.bfloat16) * 0.05)(Hq * Dh, D) * ((Hq * Dh) ** -0.5)),
        }
    _A_in = _A_setup()

    def _B_setup():
        B, S, Dm, Df = 4, 1, 640, 1728
        return {
            "x": _w((lambda *s: torch.randn(*s, dtype=torch.bfloat16) * 0.05)(B, S, Dm)),
            "w_gate": _w((lambda *s: torch.randn(*s, dtype=torch.bfloat16) * 0.8)(Dm, Df) * (Dm ** -0.5)),
            "w_up": _w((lambda *s: torch.randn(*s, dtype=torch.bfloat16) * 0.8)(Dm, Df) * (Dm ** -0.5)),
            "w_down": _w((lambda *s: torch.randn(*s, dtype=torch.bfloat16) * 0.8)(Df, Dm) * (Df ** -0.5)),
        }
    _B_in = _B_setup()

    return {
        "A_x": _A_in["x"],
        "A_k_cache": _A_in["k_cache"],
        "A_v_cache": _A_in["v_cache"],
        "A_wq": _A_in["wq"],
        "A_wo": _A_in["wo"],
        "B_x": _B_in["x"],
        "B_w_gate": _B_in["w_gate"],
        "B_w_up": _B_in["w_up"],
        "B_w_down": _B_in["w_down"],
        "gate_w": _w((lambda *s: torch.randn(*s, dtype=torch.bfloat16) * 0.05)(640) * 16.0),
    }

def reference(A_x, A_k_cache, A_v_cache, A_wq, A_wo, B_x, B_w_gate, B_w_up, B_w_down, gate_w):
    def _A_ref(x, k_cache, v_cache, wq, wo):
        B, Sq, D = x.shape
        Hq, Dh = 32, 128
        Hkv, Sk = k_cache.shape[1], k_cache.shape[2]
        W = min(4096, max(256, Sk // 4))
        rep = Hq // Hkv
        q = (lambda x, *d: x.permute(*d))((x @ wq).reshape(B, Sq, Hq, Dh), 0, 2, 1, 3)
        k = (lambda x, n, axis: torch.repeat_interleave(x, n, dim=axis))(k_cache[:, :, Sk - W:, :], rep, axis=1)
        v = (lambda x, n, axis: torch.repeat_interleave(x, n, dim=axis))(v_cache[:, :, Sk - W:, :], rep, axis=1)
        scores = torch.einsum("bhqd,bhkd->bhqk", q, k) * (Dh ** -0.5)
        p = _softmax(scores, axis=-1)
        o = torch.einsum("bhqk,bhkd->bhqd", p, v)
        return (lambda x, *d: x.permute(*d))(o, 0, 2, 1, 3).reshape(B, Sq, Hq * Dh) @ wo

    def _B_ref(x, w_gate, w_up, w_down):
        g = torch.einsum("bsd,df->bsf", x, w_gate)
        u = torch.einsum("bsd,df->bsf", x, w_up)
        h = _gelu(g) * u
        return torch.einsum("bsf,fd->bsd", h, w_down)

    x = A_x
    g = _sigmoid((x * gate_w).sum(-1, keepdims=True))
    a = _A_ref(x, A_k_cache, A_v_cache, A_wq, A_wo)
    b = _B_ref(x, B_w_gate, B_w_up, B_w_down)
    return g * a + (1 - g) * b
```

```asm
; @launch grid=(256,1,1) block=(768,1,1) lds=155648
.amdgcn_target "amdgcn-amd-amdhsa--gfx950"
.text
.globl gated_mix__sliding_block_cached__glu_gated_geglu__decode_kernel
.p2align 8
.type gated_mix__sliding_block_cached__glu_gated_geglu__decode_kernel,@function
gated_mix__sliding_block_cached__glu_gated_geglu__decode_kernel:
    s_cmp_ge_u32 s2, 256
    s_cbranch_scc1 L_exit
    s_load_dwordx16 s[16:31], s[0:1], 0
    s_load_dwordx8 s[32:39], s[0:1], 64
    s_load_dwordx2 s[40:41], s[0:1], 96
    v_lshrrev_b32 v1, 6, v0
    v_and_b32 v0, 63, v0
    v_mov_b32 v2, 0
    v_readfirstlane_b32 s3, v1
    s_and_b32 s100, s2, 31
    s_mov_b32 s6, s100
    s_lshr_b32 s9, s2, 5
    s_lshr_b32 s4, s2, 6
    s_and_b32 s7, s9, 1
    s_lshl_b32 s5, s6, 1
    s_add_u32 s5, s5, s7
    s_lshl_b32 s8, s4, 5
    s_add_u32 s8, s8, s6
    s_lshl_b32 s99, s100, 1
    s_add_u32 s99, s99, s7
    s_lshl_b32 s101, s100, 1
    s_add_u32 s101, s101, s7
    s_mul_i32 s10, s8, 0x85ebca6b
    s_lshr_b32 s10, s10, 20
    s_cmp_eq_u32 s3, 0
    s_cbranch_scc1 L_S1
    s_cmp_eq_u32 s3, 1
    s_cbranch_scc1 L_GU
    s_cmp_eq_u32 s3, 2
    s_cbranch_scc1 L_ids
    s_lshr_b32 s12, s3, 2
    s_cmp_eq_u32 s12, 1
    s_cbranch_scc1 L_K
    s_waitcnt lgkmcnt(0)
    s_barrier
    s_cmp_ge_u32 s3, 8
    s_cbranch_scc1 L_V
    s_branch L_D
L_ids:
    s_setprio 3
    s_mov_b32 s13, 1
    v_lshlrev_b32 v1, 2, v0
    ds_write_b32 v1, v2
    s_getreg_b32 s14, hwreg(HW_REG_XCC_ID)
    s_lshl_b32 s68, s6, 7
    s_add_u32 s68, s68, 524288
    s_lshl_b32 s60, s9, 3
    s_add_u32 s69, s68, s60
    s_waitcnt lgkmcnt(0)
    s_load_dword s12, s[40:41], 0
    s_mov_b32 s52, s40
    s_mov_b32 s53, s41
    s_mov_b32 s54, 4194304
    s_mov_b32 s55, 0x20000
    s_and_b32 s14, s14, 15
    v_mov_b32 v4, s14
    s_waitcnt lgkmcnt(0)
    s_and_b32 s60, s12, 0x7f7f7f7f
    s_add_u32 s60, s60, 0x01010101
    s_and_b32 s61, s12, 0x80808080
    s_xor_b32 s11, s60, s61
    v_mov_b32 v5, s11
    s_mov_b64 exec, 1
    buffer_store_dwordx2 v[4:5], v2, s[52:55], s69 offen sc1
    s_mov_b64 exec, -1
    s_barrier
    s_branch L_ids2
L_GU:
    s_cmp_lt_u32 s100, 27
    s_cbranch_scc1 L_S1
    s_barrier
    s_endpgm
L_S1:
    s_setprio 3
    v_lshrrev_b32 v3, 4, v0
    s_mul_i32 s62, s4, 160
    s_cmp_eq_u32 s7, 0
    s_cselect_b32 s63, 24, 16
    s_cselect_b32 s61, 0, 88
    s_add_u32 s62, s62, s61
    v_mul_u32_u24 v6, s63, v3
    v_add_u32 v6, s62, v6
    v_bfe_u32 v7, v0, 3, 1
    v_cmp_eq_u32 vcc, 1, v7
    v_mul_u32_u24 v5, 1280, v7
    v_lshl_add_u32 v5, v6, 1, v5
    s_mul_i32 s61, s7, 8
    v_add_u32 v6, s61, v6
    s_lshl_b32 s60, s6, 8
    s_lshl_b32 s61, s100, 7
    s_cmp_eq_u32 s3, 0
    s_movk_i32 s66, 3456
    s_cselect_b32 s66, 8192, s66
    s_cselect_b32 s60, s60, s61
    s_mov_b32 s67, 0
    v_mul_lo_u32 v6, v6, s66
    v_and_b32 v7, 7, v0
    v_lshl_add_u32 v6, v7, 4, v6
    v_add_u32 v160, s60, v6
    v_mov_b32 v161, 0
    s_waitcnt lgkmcnt(0)
    s_add_u32 s62, s22, 128
    s_addc_u32 s63, s23, 0
    s_cmp_eq_u32 s3, 0
    s_cselect_b64 s[60:61], s[22:23], s[28:29]
    s_cselect_b64 s[62:63], s[62:63], s[30:31]
    v_mov_b32 v162, s60
    v_mov_b32 v163, s61
    v_mov_b32 v6, s62
    v_mov_b32 v7, s63
    v_cndmask_b32 v162, v162, v6, vcc
    v_cndmask_b32 v163, v163, v7, vcc
    v_lshl_add_u64 v[160:161], v[160:161], 0, v[162:163]
    s_mov_b32 s44, s16
    s_mov_b32 s45, s17
    s_mov_b32 s46, 5120
    s_mov_b32 s47, 0x20000
    s_cmp_lg_u32 s7, 0
    s_cbranch_scc1 L_s1skip_1
    global_load_dwordx4 v[64:67], v[160:161], off nt
    v_lshl_add_u64 v[160:161], v[160:161], 0, s[66:67]
    global_load_dwordx4 v[68:71], v[160:161], off nt
    v_lshl_add_u64 v[160:161], v[160:161], 0, s[66:67]
    global_load_dwordx4 v[72:75], v[160:161], off nt
    v_lshl_add_u64 v[160:161], v[160:161], 0, s[66:67]
    global_load_dwordx4 v[76:79], v[160:161], off nt
    v_lshl_add_u64 v[160:161], v[160:161], 0, s[66:67]
    global_load_dwordx4 v[80:83], v[160:161], off nt
    v_lshl_add_u64 v[160:161], v[160:161], 0, s[66:67]
    global_load_dwordx4 v[84:87], v[160:161], off nt
    v_lshl_add_u64 v[160:161], v[160:161], 0, s[66:67]
    global_load_dwordx4 v[88:91], v[160:161], off nt
    v_lshl_add_u64 v[160:161], v[160:161], 0, s[66:67]
    global_load_dwordx4 v[92:95], v[160:161], off nt
    v_lshl_add_u64 v[160:161], v[160:161], 0, s[66:67]
    s_nop 1
L_s1skip_1:
    global_load_dwordx4 v[96:99], v[160:161], off nt
    v_lshl_add_u64 v[160:161], v[160:161], 0, s[66:67]
    global_load_dwordx4 v[100:103], v[160:161], off nt
    v_lshl_add_u64 v[160:161], v[160:161], 0, s[66:67]
    global_load_dwordx4 v[104:107], v[160:161], off nt
    v_lshl_add_u64 v[160:161], v[160:161], 0, s[66:67]
    global_load_dwordx4 v[108:111], v[160:161], off nt
    v_lshl_add_u64 v[160:161], v[160:161], 0, s[66:67]
    buffer_load_dwordx4 v[16:19], v5, s[44:47], 0 offen offset:0
    buffer_load_dwordx4 v[20:23], v5, s[44:47], 0 offen offset:16
    buffer_load_dwordx4 v[24:27], v5, s[44:47], 0 offen offset:32
    buffer_load_dwordx4 v[28:31], v5, s[44:47], 0 offen offset:2560
    buffer_load_dwordx4 v[32:35], v5, s[44:47], 0 offen offset:2576
    buffer_load_dwordx4 v[36:39], v5, s[44:47], 0 offen offset:2592
    global_load_dwordx4 v[112:115], v[160:161], off nt
    v_lshl_add_u64 v[160:161], v[160:161], 0, s[66:67]
    global_load_dwordx4 v[116:119], v[160:161], off nt
    v_lshl_add_u64 v[160:161], v[160:161], 0, s[66:67]
    global_load_dwordx4 v[120:123], v[160:161], off nt
    v_lshl_add_u64 v[160:161], v[160:161], 0, s[66:67]
    global_load_dwordx4 v[124:127], v[160:161], off nt
    v_lshl_add_u64 v[160:161], v[160:161], 0, s[66:67]
    global_load_dwordx4 v[128:131], v[160:161], off nt
    v_lshl_add_u64 v[160:161], v[160:161], 0, s[66:67]
    global_load_dwordx4 v[132:135], v[160:161], off nt
    v_lshl_add_u64 v[160:161], v[160:161], 0, s[66:67]
    global_load_dwordx4 v[136:139], v[160:161], off nt
    v_lshl_add_u64 v[160:161], v[160:161], 0, s[66:67]
    global_load_dwordx4 v[140:143], v[160:161], off nt
    v_lshl_add_u64 v[160:161], v[160:161], 0, s[66:67]
    global_load_dwordx4 v[144:147], v[160:161], off nt
    v_lshl_add_u64 v[160:161], v[160:161], 0, s[66:67]
    global_load_dwordx4 v[148:151], v[160:161], off nt
    v_lshl_add_u64 v[160:161], v[160:161], 0, s[66:67]
    global_load_dwordx4 v[152:155], v[160:161], off nt
    v_lshl_add_u64 v[160:161], v[160:161], 0, s[66:67]
    global_load_dwordx4 v[156:159], v[160:161], off nt
    s_barrier
    s_load_dword s12, s[40:41], 0
    v_mov_b32 v56, 0
    v_mov_b32 v57, 0
    v_mov_b32 v58, 0
    v_mov_b32 v59, 0
    v_mov_b32 v60, 0
    v_mov_b32 v61, 0
    v_mov_b32 v62, 0
    v_mov_b32 v63, 0
    v_and_b32 v5, 1, v0
    v_cmp_eq_u32 vcc, 1, v5
    v_mov_b32 v6, 0x0c0c0100
    v_mov_b32 v7, 0x01000c0c
    v_cndmask_b32 v6, v6, v7, vcc
    v_mov_b32 v5, 0x0c0c0302
    v_mov_b32 v7, 0x03020c0c
    v_cndmask_b32 v7, v5, v7, vcc
    v_bfe_u32 v5, v0, 1, 2
    v_cmp_eq_u32 vcc, 0, v5
    v_mov_b32 v8, 0x0c0c0c0c
    v_mov_b32 v12, 0x0c0c0c0c
    v_cndmask_b32 v8, v8, v6, vcc
    v_cndmask_b32 v12, v12, v7, vcc
    v_cmp_eq_u32 vcc, 1, v5
    v_mov_b32 v9, 0x0c0c0c0c
    v_mov_b32 v13, 0x0c0c0c0c
    v_cndmask_b32 v9, v9, v6, vcc
    v_cndmask_b32 v13, v13, v7, vcc
    v_cmp_eq_u32 vcc, 2, v5
    v_mov_b32 v10, 0x0c0c0c0c
    v_mov_b32 v14, 0x0c0c0c0c
    v_cndmask_b32 v10, v10, v6, vcc
    v_cndmask_b32 v14, v14, v7, vcc
    v_cmp_eq_u32 vcc, 3, v5
    v_mov_b32 v11, 0x0c0c0c0c
    v_mov_b32 v15, 0x0c0c0c0c
    v_cndmask_b32 v11, v11, v6, vcc
    v_cndmask_b32 v15, v15, v7, vcc
    s_mov_b32 s52, s40
    s_mov_b32 s53, s41
    s_mov_b32 s54, 4194304
    s_mov_b32 s55, 0x20000
    s_mov_b32 s56, 0x7060500
    s_mov_b32 s57, 0x7060501
    s_mov_b32 s58, 0x7060502
    s_mov_b32 s59, 0x7060503
    s_mov_b32 s42, 0x0c0c0400
    s_mov_b32 s43, 0x04000c0c
    s_waitcnt lgkmcnt(0)
    s_and_b32 s60, s12, 0x7f7f7f7f
    s_add_u32 s60, s60, 0x01010101
    s_and_b32 s61, s12, 0x80808080
    s_xor_b32 s11, s60, s61
    v_mov_b32 v164, s11
    v_lshrrev_b32 v5, 5, v0
    v_lshlrev_b32 v5, 12, v5
    v_and_b32 v6, 31, v0
    v_lshl_add_u32 v5, v6, 4, v5
    s_cmp_eq_u32 s3, 0
    s_mov_b32 s68, 1572864
    s_cselect_b32 s68, 1048576, s68
    s_lshl_b32 s60, s6, 14
    s_lshl_b32 s61, s9, 9
    s_add_u32 s60, s60, s61
    s_add_u32 s68, s60, s68
    s_add_u32 s69, s68, 8192
    s_waitcnt vmcnt(12)
    s_cmp_lg_u32 s7, 0
    s_cbranch_scc1 L_s1mskip_2
    v_perm_b32 v40, v16, v16, v8
    v_perm_b32 v41, v16, v16, v9
    v_perm_b32 v42, v16, v16, v10
    v_perm_b32 v43, v16, v16, v11
    v_perm_b32 v44, v28, v28, v8
    v_perm_b32 v45, v28, v28, v9
    v_perm_b32 v46, v28, v28, v10
    v_perm_b32 v47, v28, v28, v11
    v_mfma_f32_16x16x32_bf16 v[56:59], v[40:43], v[64:67], v[56:59]
    s_nop 0
    v_mfma_f32_16x16x32_bf16 v[60:63], v[44:47], v[64:67], v[60:63]
    v_perm_b32 v48, v16, v16, v12
    v_perm_b32 v49, v16, v16, v13
    v_perm_b32 v50, v16, v16, v14
    v_perm_b32 v51, v16, v16, v15
    v_perm_b32 v52, v28, v28, v12
    v_perm_b32 v53, v28, v28, v13
    v_perm_b32 v54, v28, v28, v14
    v_perm_b32 v55, v28, v28, v15
    v_mfma_f32_16x16x32_bf16 v[56:59], v[48:51], v[68:71], v[56:59]
    s_nop 0
    v_mfma_f32_16x16x32_bf16 v[60:63], v[52:55], v[68:71], v[60:63]
    v_perm_b32 v40, v17, v17, v8
    v_perm_b32 v41, v17, v17, v9
    v_perm_b32 v42, v17, v17, v10
    v_perm_b32 v43, v17, v17, v11
    v_perm_b32 v44, v29, v29, v8
    v_perm_b32 v45, v29, v29, v9
    v_perm_b32 v46, v29, v29, v10
    v_perm_b32 v47, v29, v29, v11
    v_mfma_f32_16x16x32_bf16 v[56:59], v[40:43], v[72:75], v[56:59]
    s_nop 0
    v_mfma_f32_16x16x32_bf16 v[60:63], v[44:47], v[72:75], v[60:63]
    v_perm_b32 v48, v17, v17, v12
    v_perm_b32 v49, v17, v17, v13
    v_perm_b32 v50, v17, v17, v14
    v_perm_b32 v51, v17, v17, v15
    v_perm_b32 v52, v29, v29, v12
    v_perm_b32 v53, v29, v29, v13
    v_perm_b32 v54, v29, v29, v14
    v_perm_b32 v55, v29, v29, v15
    v_mfma_f32_16x16x32_bf16 v[56:59], v[48:51], v[76:79], v[56:59]
    s_nop 0
    v_mfma_f32_16x16x32_bf16 v[60:63], v[52:55], v[76:79], v[60:63]
    v_perm_b32 v40, v18, v18, v8
    v_perm_b32 v41, v18, v18, v9
    v_perm_b32 v42, v18, v18, v10
    v_perm_b32 v43, v18, v18, v11
    v_perm_b32 v44, v30, v30, v8
    v_perm_b32 v45, v30, v30, v9
    v_perm_b32 v46, v30, v30, v10
    v_perm_b32 v47, v30, v30, v11
    v_mfma_f32_16x16x32_bf16 v[56:59], v[40:43], v[80:83], v[56:59]
    s_nop 0
    v_mfma_f32_16x16x32_bf16 v[60:63], v[44:47], v[80:83], v[60:63]
    v_perm_b32 v48, v18, v18, v12
    v_perm_b32 v49, v18, v18, v13
    v_perm_b32 v50, v18, v18, v14
    v_perm_b32 v51, v18, v18, v15
    v_perm_b32 v52, v30, v30, v12
    v_perm_b32 v53, v30, v30, v13
    v_perm_b32 v54, v30, v30, v14
    v_perm_b32 v55, v30, v30, v15
    v_mfma_f32_16x16x32_bf16 v[56:59], v[48:51], v[84:87], v[56:59]
    s_nop 0
    v_mfma_f32_16x16x32_bf16 v[60:63], v[52:55], v[84:87], v[60:63]
    v_perm_b32 v40, v19, v19, v8
    v_perm_b32 v41, v19, v19, v9
    v_perm_b32 v42, v19, v19, v10
    v_perm_b32 v43, v19, v19, v11
    v_perm_b32 v44, v31, v31, v8
    v_perm_b32 v45, v31, v31, v9
    v_perm_b32 v46, v31, v31, v10
    v_perm_b32 v47, v31, v31, v11
    v_mfma_f32_16x16x32_bf16 v[56:59], v[40:43], v[88:91], v[56:59]
    s_nop 0
    v_mfma_f32_16x16x32_bf16 v[60:63], v[44:47], v[88:91], v[60:63]
    v_perm_b32 v48, v19, v19, v12
    v_perm_b32 v49, v19, v19, v13
    v_perm_b32 v50, v19, v19, v14
    v_perm_b32 v51, v19, v19, v15
    v_perm_b32 v52, v31, v31, v12
    v_perm_b32 v53, v31, v31, v13
    v_perm_b32 v54, v31, v31, v14
    v_perm_b32 v55, v31, v31, v15
    v_mfma_f32_16x16x32_bf16 v[56:59], v[48:51], v[92:95], v[56:59]
    s_nop 0
    v_mfma_f32_16x16x32_bf16 v[60:63], v[52:55], v[92:95], v[60:63]
    s_nop 7
L_s1mskip_2:
    v_perm_b32 v40, v20, v20, v8
    v_perm_b32 v41, v20, v20, v9
    v_perm_b32 v42, v20, v20, v10
    v_perm_b32 v43, v20, v20, v11
    v_perm_b32 v44, v32, v32, v8
    v_perm_b32 v45, v32, v32, v9
    v_perm_b32 v46, v32, v32, v10
    v_perm_b32 v47, v32, v32, v11
    v_mfma_f32_16x16x32_bf16 v[56:59], v[40:43], v[96:99], v[56:59]
    s_nop 0
    v_mfma_f32_16x16x32_bf16 v[60:63], v[44:47], v[96:99], v[60:63]
    v_perm_b32 v48, v20, v20, v12
    v_perm_b32 v49, v20, v20, v13
    v_perm_b32 v50, v20, v20, v14
    v_perm_b32 v51, v20, v20, v15
    v_perm_b32 v52, v32, v32, v12
    v_perm_b32 v53, v32, v32, v13
    v_perm_b32 v54, v32, v32, v14
    v_perm_b32 v55, v32, v32, v15
    v_mfma_f32_16x16x32_bf16 v[56:59], v[48:51], v[100:103], v[56:59]
    s_nop 0
    v_mfma_f32_16x16x32_bf16 v[60:63], v[52:55], v[100:103], v[60:63]
    v_perm_b32 v40, v21, v21, v8
    v_perm_b32 v41, v21, v21, v9
    v_perm_b32 v42, v21, v21, v10
    v_perm_b32 v43, v21, v21, v11
    v_perm_b32 v44, v33, v33, v8
    v_perm_b32 v45, v33, v33, v9
    v_perm_b32 v46, v33, v33, v10
    v_perm_b32 v47, v33, v33, v11
    v_mfma_f32_16x16x32_bf16 v[56:59], v[40:43], v[104:107], v[56:59]
    s_nop 0
    v_mfma_f32_16x16x32_bf16 v[60:63], v[44:47], v[104:107], v[60:63]
    v_perm_b32 v48, v21, v21, v12
    v_perm_b32 v49, v21, v21, v13
    v_perm_b32 v50, v21, v21, v14
    v_perm_b32 v51, v21, v21, v15
    v_perm_b32 v52, v33, v33, v12
    v_perm_b32 v53, v33, v33, v13
    v_perm_b32 v54, v33, v33, v14
    v_perm_b32 v55, v33, v33, v15
    v_mfma_f32_16x16x32_bf16 v[56:59], v[48:51], v[108:111], v[56:59]
    s_nop 0
    v_mfma_f32_16x16x32_bf16 v[60:63], v[52:55], v[108:111], v[60:63]
    v_perm_b32 v40, v22, v22, v8
    v_perm_b32 v41, v22, v22, v9
    v_perm_b32 v42, v22, v22, v10
    v_perm_b32 v43, v22, v22, v11
    v_perm_b32 v44, v34, v34, v8
    v_perm_b32 v45, v34, v34, v9
    v_perm_b32 v46, v34, v34, v10
    v_perm_b32 v47, v34, v34, v11
    s_waitcnt vmcnt(11)
    v_mfma_f32_16x16x32_bf16 v[56:59], v[40:43], v[112:115], v[56:59]
    v_mfma_f32_16x16x32_bf16 v[60:63], v[44:47], v[112:115], v[60:63]
    v_perm_b32 v48, v22, v22, v12
    v_perm_b32 v49, v22, v22, v13
    v_perm_b32 v50, v22, v22, v14
    v_perm_b32 v51, v22, v22, v15
    v_perm_b32 v52, v34, v34, v12
    v_perm_b32 v53, v34, v34, v13
    v_perm_b32 v54, v34, v34, v14
    v_perm_b32 v55, v34, v34, v15
    s_waitcnt vmcnt(10)
    v_mfma_f32_16x16x32_bf16 v[56:59], v[48:51], v[116:119], v[56:59]
    v_mfma_f32_16x16x32_bf16 v[60:63], v[52:55], v[116:119], v[60:63]
    v_perm_b32 v40, v23, v23, v8
    v_perm_b32 v41, v23, v23, v9
    v_perm_b32 v42, v23, v23, v10
    v_perm_b32 v43, v23, v23, v11
    v_perm_b32 v44, v35, v35, v8
    v_perm_b32 v45, v35, v35, v9
    v_perm_b32 v46, v35, v35, v10
    v_perm_b32 v47, v35, v35, v11
    s_waitcnt vmcnt(9)
    v_mfma_f32_16x16x32_bf16 v[56:59], v[40:43], v[120:123], v[56:59]
    v_mfma_f32_16x16x32_bf16 v[60:63], v[44:47], v[120:123], v[60:63]
    v_perm_b32 v48, v23, v23, v12
    v_perm_b32 v49, v23, v23, v13
    v_perm_b32 v50, v23, v23, v14
    v_perm_b32 v51, v23, v23, v15
    v_perm_b32 v52, v35, v35, v12
    v_perm_b32 v53, v35, v35, v13
    v_perm_b32 v54, v35, v35, v14
    v_perm_b32 v55, v35, v35, v15
    s_waitcnt vmcnt(8)
    v_mfma_f32_16x16x32_bf16 v[56:59], v[48:51], v[124:127], v[56:59]
    v_mfma_f32_16x16x32_bf16 v[60:63], v[52:55], v[124:127], v[60:63]
    v_perm_b32 v40, v24, v24, v8
    v_perm_b32 v41, v24, v24, v9
    v_perm_b32 v42, v24, v24, v10
    v_perm_b32 v43, v24, v24, v11
    v_perm_b32 v44, v36, v36, v8
    v_perm_b32 v45, v36, v36, v9
    v_perm_b32 v46, v36, v36, v10
    v_perm_b32 v47, v36, v36, v11
    s_waitcnt vmcnt(7)
    v_mfma_f32_16x16x32_bf16 v[56:59], v[40:43], v[128:131], v[56:59]
    v_mfma_f32_16x16x32_bf16 v[60:63], v[44:47], v[128:131], v[60:63]
    v_perm_b32 v48, v24, v24, v12
    v_perm_b32 v49, v24, v24, v13
    v_perm_b32 v50, v24, v24, v14
    v_perm_b32 v51, v24, v24, v15
    v_perm_b32 v52, v36, v36, v12
    v_perm_b32 v53, v36, v36, v13
    v_perm_b32 v54, v36, v36, v14
    v_perm_b32 v55, v36, v36, v15
    s_waitcnt vmcnt(6)
    v_mfma_f32_16x16x32_bf16 v[56:59], v[48:51], v[132:135], v[56:59]
    v_mfma_f32_16x16x32_bf16 v[60:63], v[52:55], v[132:135], v[60:63]
    v_perm_b32 v40, v25, v25, v8
    v_perm_b32 v41, v25, v25, v9
    v_perm_b32 v42, v25, v25, v10
    v_perm_b32 v43, v25, v25, v11
    v_perm_b32 v44, v37, v37, v8
    v_perm_b32 v45, v37, v37, v9
    v_perm_b32 v46, v37, v37, v10
    v_perm_b32 v47, v37, v37, v11
    s_waitcnt vmcnt(5)
    v_mfma_f32_16x16x32_bf16 v[56:59], v[40:43], v[136:139], v[56:59]
    v_mfma_f32_16x16x32_bf16 v[60:63], v[44:47], v[136:139], v[60:63]
    v_perm_b32 v48, v25, v25, v12
    v_perm_b32 v49, v25, v25, v13
    v_perm_b32 v50, v25, v25, v14
    v_perm_b32 v51, v25, v25, v15
    v_perm_b32 v52, v37, v37, v12
    v_perm_b32 v53, v37, v37, v13
    v_perm_b32 v54, v37, v37, v14
    v_perm_b32 v55, v37, v37, v15
    s_waitcnt vmcnt(4)
    v_mfma_f32_16x16x32_bf16 v[56:59], v[48:51], v[140:143], v[56:59]
    v_mfma_f32_16x16x32_bf16 v[60:63], v[52:55], v[140:143], v[60:63]
    v_perm_b32 v40, v26, v26, v8
    v_perm_b32 v41, v26, v26, v9
    v_perm_b32 v42, v26, v26, v10
    v_perm_b32 v43, v26, v26, v11
    v_perm_b32 v44, v38, v38, v8
    v_perm_b32 v45, v38, v38, v9
    v_perm_b32 v46, v38, v38, v10
    v_perm_b32 v47, v38, v38, v11
    s_waitcnt vmcnt(3)
    v_mfma_f32_16x16x32_bf16 v[56:59], v[40:43], v[144:147], v[56:59]
    v_mfma_f32_16x16x32_bf16 v[60:63], v[44:47], v[144:147], v[60:63]
    v_perm_b32 v48, v26, v26, v12
    v_perm_b32 v49, v26, v26, v13
    v_perm_b32 v50, v26, v26, v14
    v_perm_b32 v51, v26, v26, v15
    v_perm_b32 v52, v38, v38, v12
    v_perm_b32 v53, v38, v38, v13
    v_perm_b32 v54, v38, v38, v14
    v_perm_b32 v55, v38, v38, v15
    s_waitcnt vmcnt(2)
    v_mfma_f32_16x16x32_bf16 v[56:59], v[48:51], v[148:151], v[56:59]
    v_mfma_f32_16x16x32_bf16 v[60:63], v[52:55], v[148:151], v[60:63]
    v_perm_b32 v40, v27, v27, v8
    v_perm_b32 v41, v27, v27, v9
    v_perm_b32 v42, v27, v27, v10
    v_perm_b32 v43, v27, v27, v11
    v_perm_b32 v44, v39, v39, v8
    v_perm_b32 v45, v39, v39, v9
    v_perm_b32 v46, v39, v39, v10
    v_perm_b32 v47, v39, v39, v11
    s_waitcnt vmcnt(1)
    v_mfma_f32_16x16x32_bf16 v[56:59], v[40:43], v[152:155], v[56:59]
    v_mfma_f32_16x16x32_bf16 v[60:63], v[44:47], v[152:155], v[60:63]
    v_perm_b32 v48, v27, v27, v12
    v_perm_b32 v49, v27, v27, v13
    v_perm_b32 v50, v27, v27, v14
    v_perm_b32 v51, v27, v27, v15
    v_perm_b32 v52, v39, v39, v12
    v_perm_b32 v53, v39, v39, v13
    v_perm_b32 v54, v39, v39, v14
    v_perm_b32 v55, v39, v39, v15
    s_waitcnt vmcnt(0)
    v_mfma_f32_16x16x32_bf16 v[56:59], v[48:51], v[156:159], v[56:59]
    v_mfma_f32_16x16x32_bf16 v[60:63], v[52:55], v[156:159], v[60:63]
    s_nop 6
    v_add_u32 v64, 8, v56
    v_bfi_b32 v64, 15, s11, v64
    v_add_u32 v65, 8, v57
    s_lshr_b32 s60, s11, 8
    v_bfi_b32 v65, 15, s60, v65
    v_add_u32 v66, 8, v58
    s_lshr_b32 s60, s11, 16
    v_bfi_b32 v66, 15, s60, v66
    v_add_u32 v67, 8, v59
    s_lshr_b32 s60, s11, 24
    v_bfi_b32 v67, 15, s60, v67
    v_add_u32 v68, 8, v60
    v_bfi_b32 v68, 15, s11, v68
    v_add_u32 v69, 8, v61
    s_lshr_b32 s60, s11, 8
    v_bfi_b32 v69, 15, s60, v69
    v_add_u32 v70, 8, v62
    s_lshr_b32 s60, s11, 16
    v_bfi_b32 v70, 15, s60, v70
    v_add_u32 v71, 8, v63
    s_lshr_b32 s60, s11, 24
    v_bfi_b32 v71, 15, s60, v71
    s_mov_b32 s61, 0
    s_nop 0
L_spin_3:
    ds_read_b32 v1, v2 offset:48
    s_waitcnt lgkmcnt(0)
    v_readfirstlane_b32 s60, v1
    s_nop 0
    s_cmp_ge_u32 s60, 1
    s_nop 1
    s_cbranch_scc1 L_spind_4
    s_sleep 1
    s_add_u32 s61, s61, 1
    s_cmp_lt_u32 s61, 16777216
    s_cbranch_scc1 L_spin_3
    s_mov_b32 s62, 15
    s_branch L_fail
L_spind_4:
    s_mov_b32 s77, s60
    s_cmp_lg_u32 s77, 1
    s_cbranch_scc1 L_pubr_5
    buffer_store_dwordx4 v[64:67], v5, s[52:55], s68 offen
    buffer_store_dwordx4 v[68:71], v5, s[52:55], s69 offen
    s_nop 0
    s_branch L_pubd_6
L_pubr_5:
    buffer_store_dwordx4 v[64:67], v5, s[52:55], s68 offen sc1
    buffer_store_dwordx4 v[68:71], v5, s[52:55], s69 offen sc1
    s_nop 1
L_pubd_6:
    s_cmp_lg_u32 s3, 0
    s_cbranch_scc1 L_GUrest
    v_lshlrev_b32 v5, 4, v0
    s_lshl_b32 s60, s6, 14
    s_lshl_b32 s61, s4, 12
    s_add_u32 s60, s60, s61
    s_add_u32 s68, s60, 1048576
    s_mov_b32 s61, 0
L_qpoll:
    buffer_load_dwordx4 v[60:63], v5, s[52:55], s68 offen offset:0 sc1
    buffer_load_dwordx4 v[64:67], v5, s[52:55], s68 offen offset:1024 sc1
    buffer_load_dwordx4 v[68:71], v5, s[52:55], s68 offen offset:2048 sc1
    buffer_load_dwordx4 v[72:75], v5, s[52:55], s68 offen offset:3072 sc1
    s_waitcnt vmcnt(0)
    v_perm_b32 v100, v61, v60, s42
    v_perm_b32 v101, v63, v62, s43
    v_perm_b32 v102, v65, v64, s42
    v_perm_b32 v103, v67, v66, s43
    v_perm_b32 v104, v69, v68, s42
    v_perm_b32 v105, v71, v70, s43
    v_perm_b32 v106, v73, v72, s42
    v_perm_b32 v107, v75, v74, s43
    v_or_b32 v100, v100, v101
    v_or_b32 v102, v102, v103
    v_or_b32 v104, v104, v105
    v_or_b32 v106, v106, v107
    s_mov_b32 s60, 0x0f0f0f0f
    v_mov_b32 v6, s11
    v_bfi_b32 v100, s60, v100, v6
    v_bfi_b32 v102, s60, v102, v6
    v_bfi_b32 v104, s60, v104, v6
    v_bfi_b32 v106, s60, v106, v6
    v_min_u32 v6, v100, v102
    v_max_u32 v7, v100, v102
    v_min3_u32 v6, v6, v104, v106
    v_max3_u32 v7, v7, v104, v106
    v_cmp_ne_u32 vcc, s11, v6
    v_cmp_ne_u32 s[64:65], s11, v7
    s_nop 0
    s_or_b64 s[64:65], s[64:65], vcc
    s_cmp_eq_u64 s[64:65], 0
    s_nop 0
    s_cbranch_scc1 L_tagok_7
    s_add_u32 s61, s61, 1
    s_cmp_lt_u32 s61, 2097152
    s_cbranch_scc1 L_qpoll
    s_mov_b32 s62, 1
    s_branch L_fail
L_tagok_7:
    v_and_b32 v60, 0xfffffff0, v60
    v_and_b32 v61, 0xfffffff0, v61
    v_and_b32 v62, 0xfffffff0, v62
    v_and_b32 v63, 0xfffffff0, v63
    v_and_b32 v64, 0xfffffff0, v64
    v_and_b32 v65, 0xfffffff0, v65
    v_and_b32 v66, 0xfffffff0, v66
    v_and_b32 v67, 0xfffffff0, v67
    v_and_b32 v68, 0xfffffff0, v68
    v_and_b32 v69, 0xfffffff0, v69
    v_and_b32 v70, 0xfffffff0, v70
    v_and_b32 v71, 0xfffffff0, v71
    v_and_b32 v72, 0xfffffff0, v72
    v_and_b32 v73, 0xfffffff0, v73
    v_and_b32 v74, 0xfffffff0, v74
    v_and_b32 v75, 0xfffffff0, v75
    v_add_f32 v60, v60, v64
    v_add_f32 v68, v68, v72
    v_add_f32 v61, v61, v65
    v_add_f32 v69, v69, v73
    v_add_f32 v62, v62, v66
    v_add_f32 v70, v70, v74
    v_add_f32 v63, v63, v67
    v_add_f32 v71, v71, v75
    v_add_f32 v60, v60, v68
    v_add_f32 v61, v61, v69
    v_add_f32 v62, v62, v70
    v_add_f32 v63, v63, v71
    v_mov_b32 v64, v60
    v_mov_b32 v65, v61
    v_mov_b32 v66, v62
    v_mov_b32 v67, v63
    v_permlane32_swap_b32 v60, v64
    v_permlane32_swap_b32 v61, v65
    v_permlane32_swap_b32 v62, v66
    v_permlane32_swap_b32 v63, v67
    v_add_f32 v60, v60, v64
    v_add_f32 v61, v61, v65
    v_add_f32 v62, v62, v66
    v_add_f32 v63, v63, v67
    v_cvt_pk_bf16_f32 v6, v60, v61
    v_cvt_pk_bf16_f32 v7, v62, v63
    v_and_b32 v8, 15, v0
    v_lshlrev_b32 v8, 4, v8
    v_bfe_u32 v9, v0, 4, 1
    v_lshl_add_u32 v8, v9, 3, v8
    s_mov_b32 exec_lo, 0xffffffff
    s_mov_b32 exec_hi, 0x0
    ds_write_b64 v8, v[6:7] offset:256
    s_mov_b64 exec, -1
    v_mov_b32 v6, s11
    ds_write_b32 v2, v6 offset:32
    v_mov_b32 v1, 1
    s_mov_b64 exec, 1
    ds_add_u32 v2, v1 offset:0
    s_mov_b64 exec, -1
    s_xor_b32 s60, s7, 1
    s_lshl_b32 s61, s8, 1
    s_add_u32 s60, s60, s61
    s_lshl_b32 s60, s60, 11
    s_add_u32 s68, s60, 2097152
    s_mov_b32 s61, 0
L_spin_8:
    ds_read_b32 v1, v2 offset:4
    s_waitcnt lgkmcnt(0)
    v_readfirstlane_b32 s60, v1
    s_nop 0
    s_cmp_ge_u32 s60, 4
    s_nop 1
    s_cbranch_scc1 L_spind_9
    s_sleep 1
    s_add_u32 s61, s61, 1
    s_cmp_lt_u32 s61, 16777216
    s_cbranch_scc1 L_spin_8
    s_mov_b32 s62, 2
    s_branch L_fail
L_spind_9:
    ds_read_b128 v[60:63], v5 offset:1024
    s_xor_b32 s69, s68, 2048
    v_mov_b32 v65, s11
    v_mov_b32 v67, s11
    v_mov_b32 v69, s11
    v_mov_b32 v71, s11
    s_waitcnt lgkmcnt(0)
    v_mov_b32 v64, v60
    v_mov_b32 v66, v61
    v_mov_b32 v68, v62
    v_mov_b32 v70, v63
    s_cmp_lg_u32 s77, 1
    s_cbranch_scc1 L_pubr_10
    buffer_store_dwordx4 v[64:67], v5, s[52:55], s69 offen
    buffer_store_dwordx4 v[68:71], v5, s[52:55], s69 offen offset:1024
    s_nop 0
    s_branch L_pubd_11
L_pubr_10:
    buffer_store_dwordx4 v[64:67], v5, s[52:55], s69 offen sc1
    buffer_store_dwordx4 v[68:71], v5, s[52:55], s69 offen offset:1024 sc1
    s_nop 1
L_pubd_11:
    s_mov_b32 s61, 0
L_spoll:
    buffer_load_dwordx4 v[64:67], v5, s[52:55], s68 offen sc1
    buffer_load_dwordx4 v[68:71], v5, s[52:55], s68 offen offset:1024 sc1
    s_waitcnt vmcnt(0)
    v_min_u32 v6, v65, v67
    v_max_u32 v7, v65, v67
    v_min3_u32 v6, v6, v69, v71
    v_max3_u32 v7, v7, v69, v71
    v_cmp_ne_u32 vcc, s11, v6
    v_cmp_ne_u32 s[64:65], s11, v7
    s_nop 0
    s_or_b64 s[64:65], s[64:65], vcc
    s_cmp_eq_u64 s[64:65], 0
    s_nop 0
    s_cbranch_scc1 L_tagok_12
    s_add_u32 s61, s61, 1
    s_cmp_lt_u32 s61, 2097152
    s_cbranch_scc1 L_spoll
    s_mov_b32 s62, 3
    s_branch L_fail
L_tagok_12:
    s_waitcnt lgkmcnt(0)
    v_lshlrev_b32 v72, 16, v60
    v_and_b32 v73, 0xffff0000, v60
    v_lshlrev_b32 v74, 16, v61
    v_and_b32 v75, 0xffff0000, v61
    v_lshlrev_b32 v76, 16, v62
    v_and_b32 v77, 0xffff0000, v62
    v_lshlrev_b32 v78, 16, v63
    v_and_b32 v79, 0xffff0000, v63
    v_lshlrev_b32 v80, 16, v64
    v_and_b32 v81, 0xffff0000, v64
    v_lshlrev_b32 v82, 16, v66
    v_and_b32 v83, 0xffff0000, v66
    v_lshlrev_b32 v84, 16, v68
    v_and_b32 v85, 0xffff0000, v68
    v_lshlrev_b32 v86, 16, v70
    v_and_b32 v87, 0xffff0000, v70
    v_max_f32 v6, v72, v73
    v_max3_f32 v6, v6, v74, v75
    v_max3_f32 v6, v6, v76, v77
    v_max3_f32 v6, v6, v78, v79
    v_max3_f32 v6, v6, v80, v81
    v_max3_f32 v6, v6, v82, v83
    v_max3_f32 v6, v6, v84, v85
    v_max3_f32 v6, v6, v86, v87
    s_nop 1
    v_max_f32_dpp v6, v6, v6 row_ror:1 row_mask:0xf bank_mask:0xf
    s_nop 1
    v_max_f32_dpp v6, v6, v6 row_ror:2 row_mask:0xf bank_mask:0xf
    s_nop 1
    v_max_f32_dpp v6, v6, v6 row_ror:4 row_mask:0xf bank_mask:0xf
    s_nop 1
    v_max_f32_dpp v6, v6, v6 row_ror:8 row_mask:0xf bank_mask:0xf
    v_mov_b32 v7, v6
    s_nop 1
    v_permlane16_swap_b32 v6, v7
    v_max_f32 v6, v6, v7
    v_mov_b32 v7, v6
    s_nop 1
    v_permlane32_swap_b32 v6, v7
    v_max_f32 v6, v6, v7
    s_mov_b32 s60, 0x3fb8aa3b
    v_sub_f32 v72, v72, v6
    v_sub_f32 v73, v73, v6
    v_sub_f32 v74, v74, v6
    v_sub_f32 v75, v75, v6
    v_sub_f32 v76, v76, v6
    v_sub_f32 v77, v77, v6
    v_sub_f32 v78, v78, v6
    v_sub_f32 v79, v79, v6
    v_sub_f32 v80, v80, v6
    v_sub_f32 v81, v81, v6
    v_sub_f32 v82, v82, v6
    v_sub_f32 v83, v83, v6
    v_sub_f32 v84, v84, v6
    v_sub_f32 v85, v85, v6
    v_sub_f32 v86, v86, v6
    v_sub_f32 v87, v87, v6
    v_mul_f32 v72, s60, v72
    v_mul_f32 v73, s60, v73
    v_mul_f32 v74, s60, v74
    v_mul_f32 v75, s60, v75
    v_mul_f32 v76, s60, v76
    v_mul_f32 v77, s60, v77
    v_mul_f32 v78, s60, v78
    v_mul_f32 v79, s60, v79
    v_mul_f32 v80, s60, v80
    v_mul_f32 v81, s60, v81
    v_mul_f32 v82, s60, v82
    v_mul_f32 v83, s60, v83
    v_mul_f32 v84, s60, v84
    v_mul_f32 v85, s60, v85
    v_mul_f32 v86, s60, v86
    v_mul_f32 v87, s60, v87
    v_exp_f32 v72, v72
    v_exp_f32 v73, v73
    v_exp_f32 v74, v74
    v_exp_f32 v75, v75
    v_exp_f32 v76, v76
    v_exp_f32 v77, v77
    v_exp_f32 v78, v78
    v_exp_f32 v79, v79
    v_exp_f32 v80, v80
    v_exp_f32 v81, v81
    v_exp_f32 v82, v82
    v_exp_f32 v83, v83
    v_exp_f32 v84, v84
    v_exp_f32 v85, v85
    v_exp_f32 v86, v86
    v_exp_f32 v87, v87
    v_add_f32 v6, v72, v73
    v_add_f32 v7, v74, v75
    v_add_f32 v6, v6, v76
    v_add_f32 v7, v7, v77
    v_add_f32 v6, v6, v78
    v_add_f32 v7, v7, v79
    v_add_f32 v6, v6, v80
    v_add_f32 v7, v7, v81
    v_add_f32 v6, v6, v82
    v_add_f32 v7, v7, v83
    v_add_f32 v6, v6, v84
    v_add_f32 v7, v7, v85
    v_add_f32 v6, v6, v86
    v_add_f32 v7, v7, v87
    v_add_f32 v6, v6, v7
    s_nop 1
    v_add_f32_dpp v6, v6, v6 row_ror:1 row_mask:0xf bank_mask:0xf
    s_nop 1
    v_add_f32_dpp v6, v6, v6 row_ror:2 row_mask:0xf bank_mask:0xf
    s_nop 1
    v_add_f32_dpp v6, v6, v6 row_ror:4 row_mask:0xf bank_mask:0xf
    s_nop 1
    v_add_f32_dpp v6, v6, v6 row_ror:8 row_mask:0xf bank_mask:0xf
    v_mov_b32 v7, v6
    s_nop 1
    v_permlane16_swap_b32 v6, v7
    v_add_f32 v6, v6, v7
    v_mov_b32 v7, v6
    s_nop 1
    v_permlane32_swap_b32 v6, v7
    v_add_f32 v6, v6, v7
    v_rcp_f32 v6, v6
    s_nop 0
    v_mul_f32 v72, v72, v6
    v_mul_f32 v73, v73, v6
    v_mul_f32 v74, v74, v6
    v_mul_f32 v75, v75, v6
    v_mul_f32 v76, v76, v6
    v_mul_f32 v77, v77, v6
    v_mul_f32 v78, v78, v6
    v_mul_f32 v79, v79, v6
    v_mul_f32 v80, v80, v6
    v_mul_f32 v81, v81, v6
    v_mul_f32 v82, v82, v6
    v_mul_f32 v83, v83, v6
    v_mul_f32 v84, v84, v6
    v_mul_f32 v85, v85, v6
    v_mul_f32 v86, v86, v6
    v_mul_f32 v87, v87, v6
    v_cvt_pk_bf16_f32 v60, v72, v73
    v_cvt_pk_bf16_f32 v61, v74, v75
    v_cvt_pk_bf16_f32 v62, v76, v77
    v_cvt_pk_bf16_f32 v63, v78, v79
    v_cvt_pk_bf16_f32 v64, v80, v81
    v_cvt_pk_bf16_f32 v65, v82, v83
    v_cvt_pk_bf16_f32 v66, v84, v85
    v_cvt_pk_bf16_f32 v67, v86, v87
    s_lshl_b32 s60, s7, 10
    v_add_u32 v6, s60, v5
    ds_write_b128 v6, v[60:63] offset:2048
    s_xor_b32 s60, s60, 1024
    v_add_u32 v6, s60, v5
    ds_write_b128 v6, v[64:67] offset:2048
    v_mov_b32 v1, 1
    s_mov_b64 exec, 1
    ds_add_u32 v2, v1 offset:8
    s_mov_b64 exec, -1
    s_cmp_ge_u32 s99, 40
    s_cbranch_scc1 L_Qend
    s_mul_i32 s60, s4, 20
    s_lshr_b32 s61, s99, 1
    s_add_u32 s60, s60, s61
    s_lshl_b32 s60, s60, 13
    s_and_b32 s61, s99, 1
    s_lshl_b32 s61, s61, 6
    s_add_u32 s60, s60, s61
    s_add_u32 s68, s60, 2621440
    s_add_u32 s69, s68, 4096
    s_mov_b32 s44, s36
    s_mov_b32 s45, s37
    s_mov_b32 s46, 5120
    s_mov_b32 s47, 0x20000
    v_lshlrev_b32 v9, 3, v0
    v_lshrrev_b32 v5, 2, v0
    v_lshlrev_b32 v5, 7, v5
    v_and_b32 v6, 3, v0
    v_lshl_add_u32 v5, v6, 4, v5
    s_mul_i32 s70, s4, 1280
    s_lshl_b32 s61, s99, 5
    s_add_u32 s70, s70, s61
    s_bfe_u32 s16, s11, 0x80000
    s_bfe_u32 s17, s11, 0x80008
    s_bfe_u32 s18, s11, 0x80010
    s_bfe_u32 s19, s11, 0x80018
    s_mov_b32 s61, 0
L_spin_13:
    ds_read_b32 v1, v2 offset:24
    s_waitcnt lgkmcnt(0)
    v_readfirstlane_b32 s60, v1
    s_nop 0
    s_cmp_ge_u32 s60, 4
    s_nop 1
    s_cbranch_scc1 L_spind_14
    s_sleep 1
    s_add_u32 s61, s61, 1
    s_cmp_lt_u32 s61, 16777216
    s_cbranch_scc1 L_spin_13
    s_mov_b32 s62, 4
    s_branch L_fail
L_spind_14:
    s_mov_b32 s61, 0
    buffer_load_dwordx4 v[60:63], v5, s[52:55], s68 offen offset:0 sc1
    buffer_load_dwordx4 v[64:67], v5, s[52:55], s68 offen offset:2048 sc1
    buffer_load_dwordx4 v[68:71], v5, s[52:55], s69 offen offset:0 sc1
    buffer_load_dwordx4 v[72:75], v5, s[52:55], s69 offen offset:2048 sc1
    s_sleep 6
L_fpoll:
    buffer_load_dwordx4 v[76:79], v5, s[52:55], s68 offen offset:0 sc1
    buffer_load_dwordx4 v[80:83], v5, s[52:55], s68 offen offset:2048 sc1
    buffer_load_dwordx4 v[84:87], v5, s[52:55], s69 offen offset:0 sc1
    buffer_load_dwordx4 v[88:91], v5, s[52:55], s69 offen offset:2048 sc1
    s_waitcnt vmcnt(4)
    v_xor_b32 v60, s16, v60
    v_xor_b32 v61, s17, v61
    v_xor_b32 v62, s18, v62
    v_xor_b32 v63, s19, v63
    v_xor_b32 v64, s16, v64
    v_xor_b32 v65, s17, v65
    v_xor_b32 v66, s18, v66
    v_xor_b32 v67, s19, v67
    v_xor_b32 v68, s16, v68
    v_xor_b32 v69, s17, v69
    v_xor_b32 v70, s18, v70
    v_xor_b32 v71, s19, v71
    v_xor_b32 v72, s16, v72
    v_xor_b32 v73, s17, v73
    v_xor_b32 v74, s18, v74
    v_xor_b32 v75, s19, v75
    v_or3_b32 v6, v60, v61, v62
    v_or3_b32 v7, v63, v64, v65
    v_or3_b32 v6, v6, v66, v67
    v_or3_b32 v7, v7, v68, v69
    v_or3_b32 v6, v6, v70, v71
    v_or3_b32 v7, v7, v72, v73
    v_or3_b32 v6, v6, v74, v75
    v_or_b32 v6, v6, v7
    v_and_b32 v6, 0xff, v6
    v_cmp_ne_u32 vcc, 0, v6
    v_pk_add_f32 v[152:153], v[60:61], v[64:65]
    v_pk_add_f32 v[156:157], v[68:69], v[72:73]
    v_pk_add_f32 v[154:155], v[62:63], v[66:67]
    v_pk_add_f32 v[158:159], v[70:71], v[74:75]
    s_cmp_eq_u64 vcc, 0
    s_cbranch_scc1 L_fsum
    buffer_load_dwordx4 v[60:63], v5, s[52:55], s68 offen offset:0 sc1
    buffer_load_dwordx4 v[64:67], v5, s[52:55], s68 offen offset:2048 sc1
    buffer_load_dwordx4 v[68:71], v5, s[52:55], s69 offen offset:0 sc1
    buffer_load_dwordx4 v[72:75], v5, s[52:55], s69 offen offset:2048 sc1
    s_waitcnt vmcnt(4)
    v_xor_b32 v76, s16, v76
    v_xor_b32 v77, s17, v77
    v_xor_b32 v78, s18, v78
    v_xor_b32 v79, s19, v79
    v_xor_b32 v80, s16, v80
    v_xor_b32 v81, s17, v81
    v_xor_b32 v82, s18, v82
    v_xor_b32 v83, s19, v83
    v_xor_b32 v84, s16, v84
    v_xor_b32 v85, s17, v85
    v_xor_b32 v86, s18, v86
    v_xor_b32 v87, s19, v87
    v_xor_b32 v88, s16, v88
    v_xor_b32 v89, s17, v89
    v_xor_b32 v90, s18, v90
    v_xor_b32 v91, s19, v91
    v_or3_b32 v6, v76, v77, v78
    v_or3_b32 v7, v79, v80, v81
    v_or3_b32 v6, v6, v82, v83
    v_or3_b32 v7, v7, v84, v85
    v_or3_b32 v6, v6, v86, v87
    v_or3_b32 v7, v7, v88, v89
    v_or3_b32 v6, v6, v90, v91
    v_or_b32 v6, v6, v7
    v_and_b32 v6, 0xff, v6
    v_cmp_ne_u32 vcc, 0, v6
    v_pk_add_f32 v[152:153], v[76:77], v[80:81]
    v_pk_add_f32 v[156:157], v[84:85], v[88:89]
    v_pk_add_f32 v[154:155], v[78:79], v[82:83]
    v_pk_add_f32 v[158:159], v[86:87], v[90:91]
    s_cmp_eq_u64 vcc, 0
    s_cbranch_scc1 L_fsum
    s_add_u32 s61, s61, 1
    s_cmp_lt_u32 s61, 2097152
    s_cbranch_scc1 L_fpoll
    s_mov_b32 s62, 5
    s_branch L_fail
L_fsum:
    v_pk_add_f32 v[152:153], v[152:153], v[156:157]
    v_pk_add_f32 v[154:155], v[154:155], v[158:159]
    s_nop 0
    v_add_f32_dpp v152, v152, v152 row_ror:4 row_mask:0xf bank_mask:0xf
    v_add_f32_dpp v153, v153, v153 row_ror:4 row_mask:0xf bank_mask:0xf
    v_add_f32_dpp v154, v154, v154 row_ror:4 row_mask:0xf bank_mask:0xf
    v_add_f32_dpp v155, v155, v155 row_ror:4 row_mask:0xf bank_mask:0xf
    v_add_f32_dpp v152, v152, v152 row_ror:8 row_mask:0xf bank_mask:0xf
    v_add_f32_dpp v153, v153, v153 row_ror:8 row_mask:0xf bank_mask:0xf
    v_add_f32_dpp v154, v154, v154 row_ror:8 row_mask:0xf bank_mask:0xf
    v_add_f32_dpp v155, v155, v155 row_ror:8 row_mask:0xf bank_mask:0xf
    v_mov_b32 v156, v152
    v_mov_b32 v157, v153
    v_mov_b32 v158, v154
    v_mov_b32 v159, v155
    v_permlane16_swap_b32 v152, v156
    v_permlane16_swap_b32 v153, v157
    v_permlane16_swap_b32 v154, v158
    v_permlane16_swap_b32 v155, v159
    v_pk_add_f32 v[152:153], v[152:153], v[156:157]
    v_pk_add_f32 v[154:155], v[154:155], v[158:159]
    v_mov_b32 v156, v152
    v_mov_b32 v157, v153
    v_mov_b32 v158, v154
    v_mov_b32 v159, v155
    v_permlane32_swap_b32 v152, v156
    v_permlane32_swap_b32 v153, v157
    v_permlane32_swap_b32 v154, v158
    v_permlane32_swap_b32 v155, v159
    v_pk_add_f32 v[152:153], v[152:153], v[156:157]
    v_pk_add_f32 v[154:155], v[154:155], v[158:159]
    v_cvt_pk_bf16_f32 v6, v152, v153
    v_cvt_pk_bf16_f32 v7, v154, v155
    s_mov_b64 exec, 15
    buffer_store_dwordx2 v[6:7], v9, s[44:47], s70 offen
    s_mov_b64 exec, -1
    s_cmp_lg_u32 s2, 0
    s_cbranch_scc1 L_Qend
    v_mov_b32 v6, s11
    s_mov_b64 exec, 1
    buffer_store_dword v6, v2, s[52:55], 0 offen
    s_mov_b64 exec, -1
L_Qend:
    s_endpgm
L_K:
    s_setprio 2
    s_sub_u32 s13, s3, 4
    s_lshl_b32 s70, s8, 20
    s_lshl_b32 s62, s7, 17
    s_add_u32 s62, s62, 0xC0000
    s_add_u32 s70, s70, s62
    s_lshl_b32 s62, s13, 3
    s_add_u32 s62, s62, s10
    v_lshrrev_b32 v4, 4, v0
    v_and_b32 v3, 15, v0
    v_xor_b32 v5, v3, v4
    v_xor_b32 v6, 0, v5
    v_lshlrev_b32 v6, 4, v6
    v_lshl_add_u32 v156, v4, 8, v6
    v_xor_b32 v6, 4, v5
    v_lshlrev_b32 v6, 4, v6
    v_lshl_add_u32 v157, v4, 8, v6
    v_xor_b32 v6, 8, v5
    v_lshlrev_b32 v6, 4, v6
    v_lshl_add_u32 v158, v4, 8, v6
    v_xor_b32 v6, 12, v5
    v_lshlrev_b32 v6, 4, v6
    v_lshl_add_u32 v159, v4, 8, v6
    s_lshl_b32 s15, s13, 15
    s_add_u32 s15, s15, 24576
    s_add_u32 s60, s13, 0
    s_lshl_b32 s62, s60, 1
    s_add_u32 s62, s62, s10
    s_lshr_b32 s63, s10, 3
    s_add_u32 s63, s63, s60
    s_and_b32 s63, s63, 3
    s_lshl_b32 s63, s63, 15
    s_lshr_b32 s64, s10, 4
    s_and_b32 s64, s64, 6
    s_or_b32 s64, s64, 1
    s_waitcnt lgkmcnt(0)
    s_add_u32 s44, s18, s70
    s_addc_u32 s45, s19, 0
    s_mov_b32 s46, 131072
    s_mov_b32 s47, 0x20000
    s_and_b32 s60, s62, 7
    s_lshl_b32 s60, s60, 12
    s_add_u32 s60, s60, s63
    s_add_u32 s62, s62, s64
    s_add_u32 m0, s15, 0
    s_nop 0
    buffer_load_dwordx4 v156, s[44:47], s60 offen offset:0 nt lds
    buffer_load_dwordx4 v157, s[44:47], s60 offen offset:1024 nt lds
    buffer_load_dwordx4 v158, s[44:47], s60 offen offset:2048 nt lds
    buffer_load_dwordx4 v159, s[44:47], s60 offen offset:3072 nt lds
    s_barrier
    s_and_b32 s60, s62, 7
    s_lshl_b32 s60, s60, 12
    s_add_u32 s60, s60, s63
    s_add_u32 s62, s62, s64
    s_add_u32 m0, s15, 4096
    s_nop 0
    buffer_load_dwordx4 v156, s[44:47], s60 offen offset:0 nt lds
    buffer_load_dwordx4 v157, s[44:47], s60 offen offset:1024 nt lds
    buffer_load_dwordx4 v158, s[44:47], s60 offen offset:2048 nt lds
    buffer_load_dwordx4 v159, s[44:47], s60 offen offset:3072 nt lds
    s_and_b32 s60, s62, 7
    s_lshl_b32 s60, s60, 12
    s_add_u32 s60, s60, s63
    s_add_u32 s62, s62, s64
    s_add_u32 m0, s15, 8192
    s_nop 0
    buffer_load_dwordx4 v156, s[44:47], s60 offen offset:0 nt lds
    buffer_load_dwordx4 v157, s[44:47], s60 offen offset:1024 nt lds
    buffer_load_dwordx4 v158, s[44:47], s60 offen offset:2048 nt lds
    buffer_load_dwordx4 v159, s[44:47], s60 offen offset:3072 nt lds
    s_and_b32 s60, s62, 7
    s_lshl_b32 s60, s60, 12
    s_add_u32 s60, s60, s63
    s_add_u32 s62, s62, s64
    s_add_u32 m0, s15, 12288
    s_nop 0
    buffer_load_dwordx4 v156, s[44:47], s60 offen offset:0 nt lds
    buffer_load_dwordx4 v157, s[44:47], s60 offen offset:1024 nt lds
    buffer_load_dwordx4 v158, s[44:47], s60 offen offset:2048 nt lds
    buffer_load_dwordx4 v159, s[44:47], s60 offen offset:3072 nt lds
    s_and_b32 s60, s62, 7
    s_lshl_b32 s60, s60, 12
    s_add_u32 s60, s60, s63
    s_add_u32 s62, s62, s64
    s_add_u32 m0, s15, 16384
    s_nop 0
    buffer_load_dwordx4 v156, s[44:47], s60 offen offset:0 nt lds
    buffer_load_dwordx4 v157, s[44:47], s60 offen offset:1024 nt lds
    buffer_load_dwordx4 v158, s[44:47], s60 offen offset:2048 nt lds
    buffer_load_dwordx4 v159, s[44:47], s60 offen offset:3072 nt lds
    s_and_b32 s60, s62, 7
    s_lshl_b32 s60, s60, 12
    s_add_u32 s60, s60, s63
    s_add_u32 s62, s62, s64
    s_add_u32 m0, s15, 20480
    s_nop 0
    buffer_load_dwordx4 v156, s[44:47], s60 offen offset:0 nt lds
    buffer_load_dwordx4 v157, s[44:47], s60 offen offset:1024 nt lds
    buffer_load_dwordx4 v158, s[44:47], s60 offen offset:2048 nt lds
    buffer_load_dwordx4 v159, s[44:47], s60 offen offset:3072 nt lds
    s_and_b32 s60, s62, 7
    s_lshl_b32 s60, s60, 12
    s_add_u32 s60, s60, s63
    s_add_u32 s62, s62, s64
    s_add_u32 m0, s15, 24576
    s_nop 0
    buffer_load_dwordx4 v156, s[44:47], s60 offen offset:0 nt lds
    buffer_load_dwordx4 v157, s[44:47], s60 offen offset:1024 nt lds
    buffer_load_dwordx4 v158, s[44:47], s60 offen offset:2048 nt lds
    buffer_load_dwordx4 v159, s[44:47], s60 offen offset:3072 nt lds
    s_and_b32 s60, s62, 7
    s_lshl_b32 s60, s60, 12
    s_add_u32 s60, s60, s63
    s_add_u32 s62, s62, s64
    s_add_u32 m0, s15, 28672
    s_nop 0
    buffer_load_dwordx4 v156, s[44:47], s60 offen offset:0 nt lds
    buffer_load_dwordx4 v157, s[44:47], s60 offen offset:1024 nt lds
    buffer_load_dwordx4 v158, s[44:47], s60 offen offset:2048 nt lds
    buffer_load_dwordx4 v159, s[44:47], s60 offen offset:3072 nt lds
    v_mov_b32 v1, 1
    s_mov_b64 exec, 1
    ds_add_u32 v2, v1 offset:28
    s_mov_b64 exec, -1
    s_mov_b32 s52, s40
    s_mov_b32 s53, s41
    s_mov_b32 s54, 4194304
    s_mov_b32 s55, 0x20000
    v_xor_b32 v6, 0, v5
    v_lshlrev_b32 v6, 4, v6
    v_lshl_add_u32 v6, v3, 8, v6
    v_add_u32 v156, s15, v6
    v_xor_b32 v6, 4, v5
    v_lshlrev_b32 v6, 4, v6
    v_lshl_add_u32 v6, v3, 8, v6
    v_add_u32 v157, s15, v6
    v_xor_b32 v6, 8, v5
    v_lshlrev_b32 v6, 4, v6
    v_lshl_add_u32 v6, v3, 8, v6
    v_add_u32 v158, s15, v6
    v_xor_b32 v6, 12, v5
    v_lshlrev_b32 v6, 4, v6
    v_lshl_add_u32 v6, v3, 8, v6
    v_add_u32 v159, s15, v6
    v_lshlrev_b32 v4, 4, v4
    s_mov_b32 s61, 0
    s_nop 0
L_spin_15:
    ds_read_b32 v1, v2 offset:0
    s_waitcnt lgkmcnt(0)
    v_readfirstlane_b32 s60, v1
    s_nop 0
    s_cmp_ge_u32 s60, 1
    s_nop 1
    s_cbranch_scc1 L_spind_16
    s_sleep 1
    s_add_u32 s61, s61, 1
    s_cmp_lt_u32 s61, 16777216
    s_cbranch_scc1 L_spin_15
    s_mov_b32 s62, 6
    s_branch L_fail
L_spind_16:
    ds_read_b128 v[8:11], v4 offset:256
    ds_read_b128 v[12:15], v4 offset:320
    ds_read_b128 v[16:19], v4 offset:384
    ds_read_b128 v[20:23], v4 offset:448
    ds_read_b32 v5, v2 offset:32
    s_waitcnt vmcnt(28)
    ds_read_b128 v[32:35], v156 offset:0
    ds_read_b128 v[36:39], v157 offset:0
    ds_read_b128 v[40:43], v158 offset:0
    ds_read_b128 v[44:47], v159 offset:0
    s_waitcnt vmcnt(24)
    ds_read_b128 v[48:51], v156 offset:4096
    ds_read_b128 v[52:55], v157 offset:4096
    ds_read_b128 v[56:59], v158 offset:4096
    ds_read_b128 v[60:63], v159 offset:4096
    s_waitcnt lgkmcnt(4)
    v_mfma_f32_16x16x32_bf16 v[24:27], v[8:11], v[32:35], 0
    v_mfma_f32_16x16x32_bf16 v[24:27], v[12:15], v[36:39], v[24:27]
    v_mfma_f32_16x16x32_bf16 v[24:27], v[16:19], v[40:43], v[24:27]
    v_mfma_f32_16x16x32_bf16 v[24:27], v[20:23], v[44:47], v[24:27]
    s_waitcnt vmcnt(20)
    ds_read_b128 v[64:67], v156 offset:8192
    ds_read_b128 v[68:71], v157 offset:8192
    ds_read_b128 v[72:75], v158 offset:8192
    ds_read_b128 v[76:79], v159 offset:8192
    s_waitcnt lgkmcnt(4)
    v_mfma_f32_16x16x32_bf16 v[28:31], v[8:11], v[48:51], 0
    v_mfma_f32_16x16x32_bf16 v[28:31], v[12:15], v[52:55], v[28:31]
    v_mfma_f32_16x16x32_bf16 v[28:31], v[16:19], v[56:59], v[28:31]
    v_mfma_f32_16x16x32_bf16 v[28:31], v[20:23], v[60:63], v[28:31]
    s_waitcnt vmcnt(16)
    ds_read_b128 v[32:35], v156 offset:12288
    ds_read_b128 v[36:39], v157 offset:12288
    ds_read_b128 v[40:43], v158 offset:12288
    ds_read_b128 v[44:47], v159 offset:12288
    s_waitcnt lgkmcnt(4)
    v_mfma_f32_16x16x32_bf16 v[132:135], v[8:11], v[64:67], 0
    v_mfma_f32_16x16x32_bf16 v[132:135], v[12:15], v[68:71], v[132:135]
    v_mfma_f32_16x16x32_bf16 v[132:135], v[16:19], v[72:75], v[132:135]
    v_mfma_f32_16x16x32_bf16 v[132:135], v[20:23], v[76:79], v[132:135]
    s_waitcnt vmcnt(12)
    ds_read_b128 v[48:51], v156 offset:16384
    ds_read_b128 v[52:55], v157 offset:16384
    ds_read_b128 v[56:59], v158 offset:16384
    ds_read_b128 v[60:63], v159 offset:16384
    s_waitcnt lgkmcnt(4)
    v_mfma_f32_16x16x32_bf16 v[136:139], v[8:11], v[32:35], 0
    v_mfma_f32_16x16x32_bf16 v[136:139], v[12:15], v[36:39], v[136:139]
    v_mfma_f32_16x16x32_bf16 v[136:139], v[16:19], v[40:43], v[136:139]
    v_mfma_f32_16x16x32_bf16 v[136:139], v[20:23], v[44:47], v[136:139]
    s_waitcnt vmcnt(8)
    ds_read_b128 v[64:67], v156 offset:20480
    ds_read_b128 v[68:71], v157 offset:20480
    ds_read_b128 v[72:75], v158 offset:20480
    ds_read_b128 v[76:79], v159 offset:20480
    s_waitcnt lgkmcnt(4)
    v_mfma_f32_16x16x32_bf16 v[140:143], v[8:11], v[48:51], 0
    v_mfma_f32_16x16x32_bf16 v[140:143], v[12:15], v[52:55], v[140:143]
    v_mfma_f32_16x16x32_bf16 v[140:143], v[16:19], v[56:59], v[140:143]
    v_mfma_f32_16x16x32_bf16 v[140:143], v[20:23], v[60:63], v[140:143]
    s_waitcnt vmcnt(4)
    ds_read_b128 v[32:35], v156 offset:24576
    ds_read_b128 v[36:39], v157 offset:24576
    ds_read_b128 v[40:43], v158 offset:24576
    ds_read_b128 v[44:47], v159 offset:24576
    s_waitcnt lgkmcnt(4)
    v_mfma_f32_16x16x32_bf16 v[144:147], v[8:11], v[64:67], 0
    v_mfma_f32_16x16x32_bf16 v[144:147], v[12:15], v[68:71], v[144:147]
    v_mfma_f32_16x16x32_bf16 v[144:147], v[16:19], v[72:75], v[144:147]
    v_mfma_f32_16x16x32_bf16 v[144:147], v[20:23], v[76:79], v[144:147]
    s_waitcnt vmcnt(0)
    ds_read_b128 v[48:51], v156 offset:28672
    ds_read_b128 v[52:55], v157 offset:28672
    ds_read_b128 v[56:59], v158 offset:28672
    ds_read_b128 v[60:63], v159 offset:28672
    s_waitcnt lgkmcnt(4)
    v_mfma_f32_16x16x32_bf16 v[148:151], v[8:11], v[32:35], 0
    v_mfma_f32_16x16x32_bf16 v[148:151], v[12:15], v[36:39], v[148:151]
    v_mfma_f32_16x16x32_bf16 v[148:151], v[16:19], v[40:43], v[148:151]
    v_mfma_f32_16x16x32_bf16 v[148:151], v[20:23], v[44:47], v[148:151]
    s_waitcnt lgkmcnt(0)
    v_mfma_f32_16x16x32_bf16 v[152:155], v[8:11], v[48:51], 0
    v_mfma_f32_16x16x32_bf16 v[152:155], v[12:15], v[52:55], v[152:155]
    v_mfma_f32_16x16x32_bf16 v[152:155], v[16:19], v[56:59], v[152:155]
    v_mfma_f32_16x16x32_bf16 v[152:155], v[20:23], v[60:63], v[152:155]
    s_mov_b32 s64, 0xffff0000
    s_mov_b32 s65, 0xffff0000
    s_mov_b32 s66, 0
    s_mov_b32 s67, -1
    v_cndmask_b32 v24, v24, v28, s[64:65]
    v_cndmask_b32 v132, v132, v136, s[64:65]
    v_cndmask_b32 v6, v24, v132, s[66:67]
    v_cndmask_b32 v140, v140, v144, s[64:65]
    v_cndmask_b32 v148, v148, v152, s[64:65]
    v_cndmask_b32 v7, v140, v148, s[66:67]
    v_cvt_pk_bf16_f32 v6, v6, v7
    v_and_b32 v7, 0xffff0000, v6
    v_lshlrev_b32 v6, 16, v6
    s_mov_b32 s60, 0x3db504f3
    v_mul_f32 v6, s60, v6
    v_mul_f32 v7, s60, v7
    v_cvt_pk_bf16_f32 v4, v6, v7
    v_and_b32 v6, 7, v0
    v_lshlrev_b32 v6, 3, v6
    v_lshrrev_b32 v7, 3, v0
    v_add_u32 v6, v6, v7
    s_lshl_b32 s60, s13, 6
    v_add_u32 v6, s60, v6
    v_lshlrev_b32 v6, 2, v6
    ds_write_b32 v6, v4 offset:1024
    v_mov_b32 v1, 1
    s_mov_b64 exec, 1
    ds_add_u32 v2, v1 offset:4
    s_mov_b64 exec, -1
    v_mov_b32 v26, v5
    s_setprio 1
    s_lshl_b32 s60, s6, 7
    s_lshl_b32 s61, s7, 6
    s_add_u32 s60, s60, s61
    s_lshl_b32 s61, s13, 4
    s_add_u32 s60, s60, s61
    s_mul_i32 s60, s60, 1280
    s_add_u32 s48, s24, s60
    s_addc_u32 s49, s25, 0
    s_mov_b32 s50, 20480
    s_mov_b32 s51, 0x20000
    v_lshrrev_b32 v3, 4, v0
    v_mul_u32_u24 v3, 5120, v3
    v_and_b32 v4, 15, v0
    v_lshl_add_u32 v3, v4, 4, v3
    s_movk_i32 s63, 3840
    buffer_load_dwordx4 v[32:35], v3, s[48:51], 0 offen offset:0 nt
    v_and_b32 v5, 1, v0
    buffer_load_dwordx4 v[36:39], v3, s[48:51], 0 offen offset:256 nt
    v_cmp_eq_u32 vcc, 1, v5
    buffer_load_dwordx4 v[40:43], v3, s[48:51], 0 offen offset:512 nt
    v_mov_b32 v6, 0x0c0c0100
    buffer_load_dwordx4 v[44:47], v3, s[48:51], 0 offen offset:768 nt
    v_mov_b32 v7, 0x01000c0c
    buffer_load_dwordx4 v[48:51], v3, s[48:51], 0 offen offset:1024 nt
    v_cndmask_b32 v6, v6, v7, vcc
    buffer_load_dwordx4 v[52:55], v3, s[48:51], 0 offen offset:1280 nt
    v_mov_b32 v5, 0x0c0c0302
    buffer_load_dwordx4 v[56:59], v3, s[48:51], 0 offen offset:1536 nt
    v_mov_b32 v7, 0x03020c0c
    buffer_load_dwordx4 v[60:63], v3, s[48:51], 0 offen offset:1792 nt
    v_cndmask_b32 v7, v5, v7, vcc
    s_setprio 0
    buffer_load_dwordx4 v[64:67], v3, s[48:51], 0 offen offset:2048 nt
    v_bfe_u32 v5, v0, 1, 2
    buffer_load_dwordx4 v[68:71], v3, s[48:51], 0 offen offset:2304 nt
    v_cmp_eq_u32 vcc, 0, v5
    buffer_load_dwordx4 v[72:75], v3, s[48:51], 0 offen offset:2560 nt
    v_mov_b32 v8, 0x0c0c0c0c
    buffer_load_dwordx4 v[76:79], v3, s[48:51], 0 offen offset:2816 nt
    v_mov_b32 v12, 0x0c0c0c0c
    buffer_load_dwordx4 v[80:83], v3, s[48:51], 0 offen offset:3072 nt
    v_cndmask_b32 v8, v8, v6, vcc
    buffer_load_dwordx4 v[84:87], v3, s[48:51], 0 offen offset:3328 nt
    v_cndmask_b32 v12, v12, v7, vcc
    buffer_load_dwordx4 v[88:91], v3, s[48:51], 0 offen offset:3584 nt
    v_cmp_eq_u32 vcc, 1, v5
    buffer_load_dwordx4 v[92:95], v3, s[48:51], s63 offen offset:0 nt
    v_mov_b32 v9, 0x0c0c0c0c
    buffer_load_dwordx4 v[96:99], v3, s[48:51], s63 offen offset:256 nt
    v_mov_b32 v13, 0x0c0c0c0c
    buffer_load_dwordx4 v[100:103], v3, s[48:51], s63 offen offset:512 nt
    v_cndmask_b32 v9, v9, v6, vcc
    buffer_load_dwordx4 v[104:107], v3, s[48:51], s63 offen offset:768 nt
    v_cndmask_b32 v13, v13, v7, vcc
    buffer_load_dwordx4 v[108:111], v3, s[48:51], s63 offen offset:1024 nt
    v_cmp_eq_u32 vcc, 2, v5
    v_mov_b32 v10, 0x0c0c0c0c
    v_mov_b32 v14, 0x0c0c0c0c
    v_cndmask_b32 v10, v10, v6, vcc
    v_cndmask_b32 v14, v14, v7, vcc
    v_cmp_eq_u32 vcc, 3, v5
    v_mov_b32 v11, 0x0c0c0c0c
    v_mov_b32 v15, 0x0c0c0c0c
    v_cndmask_b32 v11, v11, v6, vcc
    v_cndmask_b32 v15, v15, v7, vcc
    s_setprio 3
    s_mov_b32 s56, 0x7060500
    s_mov_b32 s57, 0x7060501
    s_mov_b32 s58, 0x7060502
    s_mov_b32 s59, 0x7060503
    s_mov_b32 s42, 0x0c0c0400
    s_mov_b32 s43, 0x04000c0c
    s_mul_i32 s14, s13, 2560
    v_and_b32 v4, 15, v0
    v_lshlrev_b32 v4, 5, v4
    v_lshrrev_b32 v6, 4, v0
    v_lshl_add_u32 v4, v6, 4, v4
    v_add_u32 v4, s14, v4
    v_lshrrev_b32 v5, 4, v0
    v_lshlrev_b32 v5, 4, v5
    s_lshl_b32 s60, s13, 6
    v_add_u32 v5, s60, v5
    v_lshlrev_b32 v27, 4, v0
    s_mul_i32 s60, s13, 640
    v_add_u32 v27, s60, v27
    v_lshrrev_b32 v28, 3, v0
    s_mul_i32 s60, s13, 5
    v_add_u32 v28, s60, v28
    v_lshlrev_b32 v28, 13, v28
    v_and_b32 v7, 7, v0
    v_lshl_add_u32 v28, v7, 4, v28
    s_mul_i32 s68, s4, 163840
    s_lshl_b32 s60, s5, 7
    s_add_u32 s68, s68, s60
    s_add_u32 s68, s68, 2621440
    s_mov_b32 s61, 0
L_spin_17:
    ds_read_b32 v1, v2 offset:12
    s_waitcnt lgkmcnt(0)
    v_readfirstlane_b32 s60, v1
    s_nop 0
    s_cmp_ge_u32 s60, 3
    s_nop 1
    s_cbranch_scc1 L_spind_18
    s_add_u32 s61, s61, 1
    s_cmp_lt_u32 s61, 16777216
    s_cbranch_scc1 L_spin_17
    s_mov_b32 s62, 7
    s_branch L_fail
L_spind_18:
    s_mov_b32 s61, 0
L_spin_19:
    ds_read_b32 v1, v2 offset:12
    ds_read_b128 v[132:135], v5 offset:4096
    ds_read_b128 v[136:139], v5 offset:4352
    ds_read_b128 v[140:143], v5 offset:4608
    ds_read_b128 v[144:147], v5 offset:4864
    ds_read_b128 v[148:151], v5 offset:5120
    ds_read_b128 v[152:155], v5 offset:5376
    ds_read_b128 v[156:159], v5 offset:5632
    ds_read_b128 v[160:163], v5 offset:5888
    s_waitcnt lgkmcnt(0)
    v_readfirstlane_b32 s60, v1
    s_nop 0
    s_cmp_ge_u32 s60, 4
    s_nop 1
    s_cbranch_scc1 L_spind_20
    s_add_u32 s61, s61, 1
    s_cmp_lt_u32 s61, 16777216
    s_cbranch_scc1 L_spin_19
    s_mov_b32 s62, 7
    s_branch L_fail
L_spind_20:
    v_pk_add_f32 v[132:133], v[132:133], v[148:149]
    v_pk_add_f32 v[134:135], v[134:135], v[150:151]
    v_pk_add_f32 v[136:137], v[136:137], v[152:153]
    v_pk_add_f32 v[138:139], v[138:139], v[154:155]
    v_pk_add_f32 v[140:141], v[140:141], v[156:157]
    v_pk_add_f32 v[142:143], v[142:143], v[158:159]
    v_pk_add_f32 v[144:145], v[144:145], v[160:161]
    v_pk_add_f32 v[146:147], v[146:147], v[162:163]
    v_pk_add_f32 v[132:133], v[132:133], v[140:141]
    v_pk_add_f32 v[134:135], v[134:135], v[142:143]
    v_pk_add_f32 v[136:137], v[136:137], v[144:145]
    v_pk_add_f32 v[138:139], v[138:139], v[146:147]
    v_pk_add_f32 v[132:133], v[132:133], v[136:137]
    v_pk_add_f32 v[134:135], v[134:135], v[138:139]
    v_cvt_pk_bf16_f32 v24, v132, v133
    v_cvt_pk_bf16_f32 v25, v134, v135
    v_perm_b32 v16, v24, v24, v8
    v_perm_b32 v17, v24, v24, v9
    v_perm_b32 v18, v24, v24, v10
    v_perm_b32 v19, v24, v24, v11
    s_waitcnt vmcnt(19)
    s_nop 0
    v_mfma_f32_16x16x32_bf16 v[112:115], v[16:19], v[32:35], 0
    s_waitcnt vmcnt(18)
    v_mfma_f32_16x16x32_bf16 v[116:119], v[16:19], v[36:39], 0
    s_waitcnt vmcnt(17)
    v_mfma_f32_16x16x32_bf16 v[120:123], v[16:19], v[40:43], 0
    s_waitcnt vmcnt(16)
    v_mfma_f32_16x16x32_bf16 v[124:127], v[16:19], v[44:47], 0
    s_waitcnt vmcnt(15)
    v_mfma_f32_16x16x32_bf16 v[128:131], v[16:19], v[48:51], 0
    v_perm_b32 v20, v24, v24, v12
    v_perm_b32 v21, v24, v24, v13
    v_perm_b32 v22, v24, v24, v14
    v_perm_b32 v23, v24, v24, v15
    s_waitcnt vmcnt(14)
    s_nop 0
    v_mfma_f32_16x16x32_bf16 v[112:115], v[20:23], v[52:55], v[112:115]
    s_waitcnt vmcnt(13)
    v_mfma_f32_16x16x32_bf16 v[116:119], v[20:23], v[56:59], v[116:119]
    s_waitcnt vmcnt(12)
    v_mfma_f32_16x16x32_bf16 v[120:123], v[20:23], v[60:63], v[120:123]
    s_waitcnt vmcnt(11)
    v_mfma_f32_16x16x32_bf16 v[124:127], v[20:23], v[64:67], v[124:127]
    s_waitcnt vmcnt(10)
    v_mfma_f32_16x16x32_bf16 v[128:131], v[20:23], v[68:71], v[128:131]
    v_perm_b32 v16, v25, v25, v8
    v_perm_b32 v17, v25, v25, v9
    v_perm_b32 v18, v25, v25, v10
    v_perm_b32 v19, v25, v25, v11
    s_waitcnt vmcnt(9)
    s_nop 0
    v_mfma_f32_16x16x32_bf16 v[112:115], v[16:19], v[72:75], v[112:115]
    s_waitcnt vmcnt(8)
    v_mfma_f32_16x16x32_bf16 v[116:119], v[16:19], v[76:79], v[116:119]
    s_waitcnt vmcnt(7)
    v_mfma_f32_16x16x32_bf16 v[120:123], v[16:19], v[80:83], v[120:123]
    s_waitcnt vmcnt(6)
    v_mfma_f32_16x16x32_bf16 v[124:127], v[16:19], v[84:87], v[124:127]
    s_waitcnt vmcnt(5)
    v_mfma_f32_16x16x32_bf16 v[128:131], v[16:19], v[88:91], v[128:131]
    v_perm_b32 v20, v25, v25, v12
    v_perm_b32 v21, v25, v25, v13
    v_perm_b32 v22, v25, v25, v14
    v_perm_b32 v23, v25, v25, v15
    s_waitcnt vmcnt(4)
    s_nop 0
    v_mfma_f32_16x16x32_bf16 v[112:115], v[20:23], v[92:95], v[112:115]
    s_waitcnt vmcnt(3)
    v_mfma_f32_16x16x32_bf16 v[116:119], v[20:23], v[96:99], v[116:119]
    s_waitcnt vmcnt(2)
    v_mfma_f32_16x16x32_bf16 v[120:123], v[20:23], v[100:103], v[120:123]
    s_waitcnt vmcnt(1)
    v_mfma_f32_16x16x32_bf16 v[124:127], v[20:23], v[104:107], v[124:127]
    s_waitcnt vmcnt(0)
    v_mfma_f32_16x16x32_bf16 v[128:131], v[20:23], v[108:111], v[128:131]
    s_mov_b32 exec_lo, 0xffffffff
    s_mov_b32 exec_hi, 0x0
    ds_write_b128 v4, v[112:115] offset:6144
    ds_write_b128 v4, v[116:119] offset:6656
    ds_write_b128 v4, v[120:123] offset:7168
    s_nop 0
    ds_write_b128 v4, v[124:127] offset:7680
    s_nop 0
    ds_write_b128 v4, v[128:131] offset:8192
    s_mov_b64 exec, -1
    v_mov_b32 v1, 1
    s_mov_b64 exec, 1
    ds_add_u32 v2, v1 offset:20
    s_mov_b64 exec, -1
    s_mov_b32 exec_lo, 0xffffffff
    s_mov_b32 exec_hi, 0xff
    s_mov_b32 s61, 0
L_spin_21:
    ds_read_b32 v1, v2 offset:20
    ds_read_b128 v[32:35], v27 offset:6144
    ds_read_b128 v[36:39], v27 offset:8704
    ds_read_b128 v[40:43], v27 offset:11264
    ds_read_b128 v[44:47], v27 offset:13824
    ds_read_b128 v[48:51], v27 offset:16384
    ds_read_b128 v[52:55], v27 offset:18944
    ds_read_b64 v[56:57], v2 offset:40
    s_waitcnt lgkmcnt(0)
    v_readfirstlane_b32 s60, v1
    s_nop 0
    s_cmp_ge_u32 s60, 6
    s_nop 1
    s_cbranch_scc1 L_spind_22
    s_add_u32 s61, s61, 1
    s_cmp_lt_u32 s61, 16777216
    s_cbranch_scc1 L_spin_21
    s_mov_b32 s62, 8
    s_branch L_fail
L_spind_22:
    v_pk_add_f32 v[32:33], v[32:33], v[36:37]
    v_pk_add_f32 v[40:41], v[40:41], v[44:45]
    v_pk_add_f32 v[48:49], v[48:49], v[52:53]
    v_pk_add_f32 v[34:35], v[34:35], v[38:39]
    v_pk_add_f32 v[42:43], v[42:43], v[46:47]
    v_pk_add_f32 v[50:51], v[50:51], v[54:55]
    v_pk_add_f32 v[32:33], v[32:33], v[40:41]
    v_pk_add_f32 v[34:35], v[34:35], v[42:43]
    v_mul_f32 v48, v48, v57
    v_mul_f32 v49, v49, v57
    v_mul_f32 v50, v50, v57
    v_mul_f32 v51, v51, v57
    v_fma_f32 v32, v32, v56, v48
    v_fma_f32 v33, v33, v56, v49
    v_fma_f32 v34, v34, v56, v50
    v_fma_f32 v35, v35, v56, v51
    v_add_u32 v64, 0x80, v32
    v_perm_b32 v64, v64, v26, s56
    v_add_u32 v65, 0x80, v33
    v_perm_b32 v65, v65, v26, s57
    v_add_u32 v66, 0x80, v34
    v_perm_b32 v66, v66, v26, s58
    v_add_u32 v67, 0x80, v35
    v_perm_b32 v67, v67, v26, s59
    buffer_store_dwordx4 v[64:67], v28, s[52:55], s68 offen sc1
    s_mov_b64 exec, -1
    v_mov_b32 v1, 1
    s_mov_b64 exec, 1
    ds_add_u32 v2, v1 offset:24
    s_mov_b64 exec, -1
    s_endpgm
L_GUrest:
    v_lshrrev_b32 v5, 2, v0
    v_lshlrev_b32 v5, 7, v5
    v_and_b32 v6, 3, v0
    v_lshl_add_u32 v5, v6, 4, v5
    s_lshl_b32 s60, s6, 14
    s_lshl_b32 s61, s4, 12
    s_add_u32 s60, s60, s61
    s_lshl_b32 s61, s7, 6
    s_add_u32 s60, s60, s61
    s_add_u32 s68, s60, 1572864
    s_mov_b32 s61, 0
L_gpoll:
    buffer_load_dwordx4 v[60:63], v5, s[52:55], s68 offen sc1
    buffer_load_dwordx4 v[64:67], v5, s[52:55], s68 offen offset:2048 sc1
    s_waitcnt vmcnt(0)
    v_perm_b32 v100, v61, v60, s42
    v_perm_b32 v101, v63, v62, s43
    v_perm_b32 v102, v65, v64, s42
    v_perm_b32 v103, v67, v66, s43
    v_or_b32 v100, v100, v101
    v_or_b32 v102, v102, v103
    s_mov_b32 s60, 0x0f0f0f0f
    v_mov_b32 v6, s11
    v_bfi_b32 v100, s60, v100, v6
    v_bfi_b32 v102, s60, v102, v6
    v_min_u32 v6, v100, v102
    v_max_u32 v7, v100, v102
    v_cmp_ne_u32 vcc, s11, v6
    v_cmp_ne_u32 s[64:65], s11, v7
    s_nop 0
    s_or_b64 s[64:65], s[64:65], vcc
    s_cmp_eq_u64 s[64:65], 0
    s_nop 0
    s_cbranch_scc1 L_tagok_23
    s_sleep 16
    s_add_u32 s61, s61, 1
    s_cmp_lt_u32 s61, 2097152
    s_cbranch_scc1 L_gpoll
    s_mov_b32 s62, 9
    s_branch L_fail
L_tagok_23:
    v_and_b32 v60, 0xfffffff0, v60
    v_and_b32 v61, 0xfffffff0, v61
    v_and_b32 v62, 0xfffffff0, v62
    v_and_b32 v63, 0xfffffff0, v63
    v_and_b32 v64, 0xfffffff0, v64
    v_and_b32 v65, 0xfffffff0, v65
    v_and_b32 v66, 0xfffffff0, v66
    v_and_b32 v67, 0xfffffff0, v67
    v_add_f32 v60, v60, v64
    v_add_f32 v61, v61, v65
    v_add_f32 v62, v62, v66
    v_add_f32 v63, v63, v67
    v_mov_b32 v64, v60
    v_mov_b32 v65, v61
    v_mov_b32 v66, v62
    v_mov_b32 v67, v63
    v_permlane16_swap_b32 v60, v64
    v_permlane16_swap_b32 v61, v65
    v_permlane16_swap_b32 v62, v66
    v_permlane16_swap_b32 v63, v67
    v_add_f32 v60, v60, v64
    v_add_f32 v61, v61, v65
    v_add_f32 v62, v62, v66
    v_add_f32 v63, v63, v67
    v_mov_b32 v64, v60
    v_mov_b32 v65, v61
    v_mov_b32 v66, v62
    v_mov_b32 v67, v63
    v_permlane32_swap_b32 v60, v64
    v_permlane32_swap_b32 v61, v65
    v_permlane32_swap_b32 v62, v66
    v_permlane32_swap_b32 v63, v67
    v_add_f32 v60, v60, v64
    v_add_f32 v61, v61, v65
    v_add_f32 v62, v62, v66
    v_add_f32 v63, v63, v67
    v_cvt_pk_bf16_f32 v64, v60, v61
    v_cvt_pk_bf16_f32 v65, v62, v63
    v_lshlrev_b32 v60, 16, v64
    v_and_b32 v61, 0xffff0000, v64
    v_lshlrev_b32 v62, 16, v65
    v_and_b32 v63, 0xffff0000, v65
    v_mov_b32_dpp v64, v60 row_shl:4 row_mask:0xf bank_mask:0xf
    v_mov_b32_dpp v65, v61 row_shl:4 row_mask:0xf bank_mask:0xf
    v_mov_b32_dpp v66, v62 row_shl:4 row_mask:0xf bank_mask:0xf
    v_mov_b32_dpp v67, v63 row_shl:4 row_mask:0xf bank_mask:0xf
    s_mov_b32 s60, 0x3d372713
    s_mov_b32 s61, 0xc0135761
    v_mul_f32 v68, v60, v60
    v_mul_f32 v68, v68, v60
    v_fma_f32 v68, v68, s60, v60
    v_mul_f32 v68, s61, v68
    v_exp_f32 v68, v68
    s_nop 0
    v_add_f32 v68, 1.0, v68
    v_rcp_f32 v68, v68
    s_nop 0
    v_mul_f32 v60, v60, v68
    v_mul_f32 v69, v61, v61
    v_mul_f32 v69, v69, v61
    v_fma_f32 v69, v69, s60, v61
    v_mul_f32 v69, s61, v69
    v_exp_f32 v69, v69
    s_nop 0
    v_add_f32 v69, 1.0, v69
    v_rcp_f32 v69, v69
    s_nop 0
    v_mul_f32 v61, v61, v69
    v_mul_f32 v70, v62, v62
    v_mul_f32 v70, v70, v62
    v_fma_f32 v70, v70, s60, v62
    v_mul_f32 v70, s61, v70
    v_exp_f32 v70, v70
    s_nop 0
    v_add_f32 v70, 1.0, v70
    v_rcp_f32 v70, v70
    s_nop 0
    v_mul_f32 v62, v62, v70
    v_mul_f32 v71, v63, v63
    v_mul_f32 v71, v71, v63
    v_fma_f32 v71, v71, s60, v63
    v_mul_f32 v71, s61, v71
    v_exp_f32 v71, v71
    s_nop 0
    v_add_f32 v71, 1.0, v71
    v_rcp_f32 v71, v71
    s_nop 0
    v_mul_f32 v63, v63, v71
    v_cvt_pk_bf16_f32 v68, v60, v61
    v_cvt_pk_bf16_f32 v69, v62, v63
    v_lshlrev_b32 v60, 16, v68
    v_and_b32 v61, 0xffff0000, v68
    v_lshlrev_b32 v62, 16, v69
    v_and_b32 v63, 0xffff0000, v69
    v_mul_f32 v60, v60, v64
    v_mul_f32 v61, v61, v65
    v_mul_f32 v62, v62, v66
    v_mul_f32 v63, v63, v67
    v_cvt_pk_bf16_f32 v60, v60, v61
    v_cvt_pk_bf16_f32 v61, v62, v63
    v_and_b32 v6, 3, v0
    v_lshlrev_b32 v6, 4, v6
    v_bfe_u32 v7, v0, 3, 1
    v_lshl_add_u32 v6, v7, 3, v6
    s_mov_b32 exec_lo, 0xf0f
    s_mov_b32 exec_hi, 0x0
    ds_write_b64 v6, v[60:61] offset:512
    s_mov_b64 exec, -1
    v_mov_b32 v1, 1
    s_mov_b64 exec, 1
    ds_add_u32 v2, v1 offset:16
    s_mov_b64 exec, -1
    s_endpgm
L_V:
    s_setprio 1
    s_sub_u32 s13, s3, 8
    s_lshl_b32 s60, s8, 20
    s_lshr_b32 s61, s8, 12
    s_lshl_b32 s62, s7, 7
    s_add_u32 s62, s62, 0xC0000
    s_add_u32 s60, s60, s62
    s_addc_u32 s61, s61, 0
    s_add_u32 s44, s20, s60
    s_addc_u32 s45, s21, s61
    s_mov_b32 s46, 262016
    s_mov_b32 s47, 0x20000
    v_lshrrev_b32 v3, 3, v0
    v_lshlrev_b32 v4, 5, v3
    v_lshlrev_b32 v3, 8, v3
    v_and_b32 v5, 7, v0
    v_lshl_add_u32 v3, v5, 4, v3
    s_and_b32 s15, s13, 1
    s_lshl_b32 s15, s15, 4
    s_add_u32 s15, s15, s10
    s_lshr_b32 s63, s13, 1
    s_lshl_b32 s63, s63, 17
    v_and_b32 v5, 1, v0
    v_cmp_eq_u32 vcc, 1, v5
    v_mov_b32 v6, 0x0c0c0100
    v_mov_b32 v7, 0x01000c0c
    v_cndmask_b32 v6, v6, v7, vcc
    v_mov_b32 v5, 0x0c0c0302
    v_mov_b32 v7, 0x03020c0c
    v_cndmask_b32 v7, v5, v7, vcc
    v_bfe_u32 v5, v0, 1, 2
    v_cmp_eq_u32 vcc, 0, v5
    v_mov_b32 v8, 0x0c0c0c0c
    v_mov_b32 v12, 0x0c0c0c0c
    v_cndmask_b32 v8, v8, v6, vcc
    v_cndmask_b32 v12, v12, v7, vcc
    v_cmp_eq_u32 vcc, 1, v5
    v_mov_b32 v9, 0x0c0c0c0c
    v_mov_b32 v13, 0x0c0c0c0c
    v_cndmask_b32 v9, v9, v6, vcc
    v_cndmask_b32 v13, v13, v7, vcc
    v_cmp_eq_u32 vcc, 2, v5
    v_mov_b32 v10, 0x0c0c0c0c
    v_mov_b32 v14, 0x0c0c0c0c
    v_cndmask_b32 v10, v10, v6, vcc
    v_cndmask_b32 v14, v14, v7, vcc
    v_cmp_eq_u32 vcc, 3, v5
    v_mov_b32 v11, 0x0c0c0c0c
    v_mov_b32 v15, 0x0c0c0c0c
    v_cndmask_b32 v11, v11, v6, vcc
    v_cndmask_b32 v15, v15, v7, vcc
    s_mov_b32 s61, 0
    s_nop 0
L_spin_24:
    ds_read_b32 v1, v2 offset:28
    s_waitcnt lgkmcnt(0)
    v_readfirstlane_b32 s60, v1
    s_nop 0
    s_cmp_ge_u32 s60, 2
    s_nop 1
    s_cbranch_scc1 L_spind_25
    s_sleep 1
    s_add_u32 s61, s61, 1
    s_cmp_lt_u32 s61, 16777216
    s_cbranch_scc1 L_spin_24
    s_mov_b32 s62, 13
    s_branch L_fail
L_spind_25:
    s_and_b32 s15, s13, 1
    s_lshl_b32 s15, s15, 1
    s_add_u32 s60, s15, 0
    s_lshl_b32 s64, s60, 1
    s_add_u32 s64, s64, s10
    s_lshr_b32 s65, s10, 3
    s_add_u32 s65, s65, s60
    s_and_b32 s65, s65, 3
    s_lshl_b32 s65, s65, 15
    s_lshr_b32 s66, s10, 4
    s_and_b32 s66, s66, 6
    s_or_b32 s66, s66, 1
    s_add_u32 s65, s65, s63
    s_and_b32 s60, s64, 7
    s_lshl_b32 s60, s60, 12
    s_add_u32 s60, s60, s65
    s_add_u32 s64, s64, s66
    buffer_load_dwordx4 v[32:35], v3, s[44:47], s60 offen offset:0 nt
    buffer_load_dwordx4 v[36:39], v3, s[44:47], s60 offen offset:2048 nt
    s_and_b32 s60, s64, 7
    s_lshl_b32 s60, s60, 12
    s_add_u32 s60, s60, s65
    s_add_u32 s64, s64, s66
    buffer_load_dwordx4 v[40:43], v3, s[44:47], s60 offen offset:0 nt
    buffer_load_dwordx4 v[44:47], v3, s[44:47], s60 offen offset:2048 nt
    s_and_b32 s60, s64, 7
    s_lshl_b32 s60, s60, 12
    s_add_u32 s60, s60, s65
    s_add_u32 s64, s64, s66
    buffer_load_dwordx4 v[48:51], v3, s[44:47], s60 offen offset:0 nt
    buffer_load_dwordx4 v[52:55], v3, s[44:47], s60 offen offset:2048 nt
    s_and_b32 s60, s64, 7
    s_lshl_b32 s60, s60, 12
    s_add_u32 s60, s60, s65
    s_add_u32 s64, s64, s66
    buffer_load_dwordx4 v[56:59], v3, s[44:47], s60 offen offset:0 nt
    buffer_load_dwordx4 v[60:63], v3, s[44:47], s60 offen offset:2048 nt
    s_and_b32 s60, s64, 7
    s_lshl_b32 s60, s60, 12
    s_add_u32 s60, s60, s65
    s_add_u32 s64, s64, s66
    buffer_load_dwordx4 v[64:67], v3, s[44:47], s60 offen offset:0 nt
    buffer_load_dwordx4 v[68:71], v3, s[44:47], s60 offen offset:2048 nt
    s_and_b32 s60, s64, 7
    s_lshl_b32 s60, s60, 12
    s_add_u32 s60, s60, s65
    s_add_u32 s64, s64, s66
    buffer_load_dwordx4 v[72:75], v3, s[44:47], s60 offen offset:0 nt
    buffer_load_dwordx4 v[76:79], v3, s[44:47], s60 offen offset:2048 nt
    s_and_b32 s60, s64, 7
    s_lshl_b32 s60, s60, 12
    s_add_u32 s60, s60, s65
    s_add_u32 s64, s64, s66
    buffer_load_dwordx4 v[80:83], v3, s[44:47], s60 offen offset:0 nt
    buffer_load_dwordx4 v[84:87], v3, s[44:47], s60 offen offset:2048 nt
    s_and_b32 s60, s64, 7
    s_lshl_b32 s60, s60, 12
    s_add_u32 s60, s60, s65
    s_add_u32 s64, s64, s66
    buffer_load_dwordx4 v[88:91], v3, s[44:47], s60 offen offset:0 nt
    buffer_load_dwordx4 v[92:95], v3, s[44:47], s60 offen offset:2048 nt
    s_and_b32 s15, s13, 1
    s_lshl_b32 s15, s15, 1
    s_add_u32 s60, s15, 1
    s_lshl_b32 s64, s60, 1
    s_add_u32 s64, s64, s10
    s_lshr_b32 s65, s10, 3
    s_add_u32 s65, s65, s60
    s_and_b32 s65, s65, 3
    s_lshl_b32 s65, s65, 15
    s_lshr_b32 s66, s10, 4
    s_and_b32 s66, s66, 6
    s_or_b32 s66, s66, 1
    s_add_u32 s65, s65, s63
    s_and_b32 s60, s64, 7
    s_lshl_b32 s60, s60, 12
    s_add_u32 s60, s60, s65
    s_add_u32 s64, s64, s66
    buffer_load_dwordx4 v[96:99], v3, s[44:47], s60 offen offset:0 nt
    buffer_load_dwordx4 v[100:103], v3, s[44:47], s60 offen offset:2048 nt
    s_and_b32 s60, s64, 7
    s_lshl_b32 s60, s60, 12
    s_add_u32 s60, s60, s65
    s_add_u32 s64, s64, s66
    buffer_load_dwordx4 v[104:107], v3, s[44:47], s60 offen offset:0 nt
    buffer_load_dwordx4 v[108:111], v3, s[44:47], s60 offen offset:2048 nt
    s_and_b32 s60, s64, 7
    s_lshl_b32 s60, s60, 12
    s_add_u32 s60, s60, s65
    s_add_u32 s64, s64, s66
    buffer_load_dwordx4 v[112:115], v3, s[44:47], s60 offen offset:0 nt
    buffer_load_dwordx4 v[116:119], v3, s[44:47], s60 offen offset:2048 nt
    s_and_b32 s60, s64, 7
    s_lshl_b32 s60, s60, 12
    s_add_u32 s60, s60, s65
    s_add_u32 s64, s64, s66
    buffer_load_dwordx4 v[120:123], v3, s[44:47], s60 offen offset:0 nt
    buffer_load_dwordx4 v[124:127], v3, s[44:47], s60 offen offset:2048 nt
    s_and_b32 s60, s64, 7
    s_lshl_b32 s60, s60, 12
    s_add_u32 s60, s60, s65
    s_add_u32 s64, s64, s66
    buffer_load_dwordx4 v[128:131], v3, s[44:47], s60 offen offset:0 nt
    buffer_load_dwordx4 v[132:135], v3, s[44:47], s60 offen offset:2048 nt
    s_and_b32 s60, s64, 7
    s_lshl_b32 s60, s60, 12
    s_add_u32 s60, s60, s65
    s_add_u32 s64, s64, s66
    buffer_load_dwordx4 v[136:139], v3, s[44:47], s60 offen offset:0 nt
    buffer_load_dwordx4 v[140:143], v3, s[44:47], s60 offen offset:2048 nt
    s_and_b32 s60, s64, 7
    s_lshl_b32 s60, s60, 12
    s_add_u32 s60, s60, s65
    s_add_u32 s64, s64, s66
    buffer_load_dwordx4 v[144:147], v3, s[44:47], s60 offen offset:0 nt
    buffer_load_dwordx4 v[148:151], v3, s[44:47], s60 offen offset:2048 nt
    s_and_b32 s60, s64, 7
    s_lshl_b32 s60, s60, 12
    s_add_u32 s60, s60, s65
    s_add_u32 s64, s64, s66
    buffer_load_dwordx4 v[152:155], v3, s[44:47], s60 offen offset:0 nt
    buffer_load_dwordx4 v[156:159], v3, s[44:47], s60 offen offset:2048 nt
    s_setprio 3
    s_lshl_b32 s14, s13, 9
    v_add_u32 v3, s14, v4
    s_mov_b32 s61, 0
    s_nop 0
L_spin_26:
    ds_read_b32 v1, v2 offset:8
    s_waitcnt lgkmcnt(0)
    v_readfirstlane_b32 s60, v1
    s_nop 0
    s_cmp_ge_u32 s60, 1
    s_nop 1
    s_cbranch_scc1 L_spind_27
    s_sleep 1
    s_add_u32 s61, s61, 1
    s_cmp_lt_u32 s61, 16777216
    s_cbranch_scc1 L_spin_26
    s_mov_b32 s62, 10
    s_branch L_fail
L_spind_27:
    ds_read_b128 v[16:19], v3 offset:2048
    ds_read_b128 v[20:23], v3 offset:2064
    ds_read_b128 v[24:27], v3 offset:2304
    ds_read_b128 v[28:31], v3 offset:2320
    s_waitcnt lgkmcnt(0)
    v_and_b32 v3, 7, v0
    v_lshlrev_b32 v3, 5, v3
    v_bfe_u32 v1, v0, 4, 1
    v_lshl_add_u32 v3, v1, 4, v3
    v_lshrrev_b32 v1, 5, v0
    v_lshl_add_u32 v3, v1, 8, v3
    v_add_u32 v3, s14, v3
    v_perm_b32 v160, v16, v16, v8
    v_perm_b32 v161, v16, v16, v9
    v_perm_b32 v162, v16, v16, v10
    v_perm_b32 v163, v16, v16, v11
    s_waitcnt vmcnt(31)
    s_nop 0
    v_mfma_f32_16x16x32_bf16 v[4:7], v[160:163], v[32:35], 0
    v_perm_b32 v164, v17, v17, v8
    v_perm_b32 v165, v17, v17, v9
    v_perm_b32 v166, v17, v17, v10
    v_perm_b32 v167, v17, v17, v11
    s_waitcnt vmcnt(30)
    s_nop 0
    v_mfma_f32_16x16x32_bf16 v[4:7], v[164:167], v[36:39], v[4:7]
    v_perm_b32 v160, v18, v18, v8
    v_perm_b32 v161, v18, v18, v9
    v_perm_b32 v162, v18, v18, v10
    v_perm_b32 v163, v18, v18, v11
    s_waitcnt vmcnt(29)
    s_nop 0
    v_mfma_f32_16x16x32_bf16 v[4:7], v[160:163], v[40:43], v[4:7]
    v_perm_b32 v164, v19, v19, v8
    v_perm_b32 v165, v19, v19, v9
    v_perm_b32 v166, v19, v19, v10
    v_perm_b32 v167, v19, v19, v11
    s_waitcnt vmcnt(28)
    s_nop 0
    v_mfma_f32_16x16x32_bf16 v[4:7], v[164:167], v[44:47], v[4:7]
    v_perm_b32 v160, v20, v20, v8
    v_perm_b32 v161, v20, v20, v9
    v_perm_b32 v162, v20, v20, v10
    v_perm_b32 v163, v20, v20, v11
    s_waitcnt vmcnt(27)
    s_nop 0
    v_mfma_f32_16x16x32_bf16 v[4:7], v[160:163], v[48:51], v[4:7]
    v_perm_b32 v164, v21, v21, v8
    v_perm_b32 v165, v21, v21, v9
    v_perm_b32 v166, v21, v21, v10
    v_perm_b32 v167, v21, v21, v11
    s_waitcnt vmcnt(26)
    s_nop 0
    v_mfma_f32_16x16x32_bf16 v[4:7], v[164:167], v[52:55], v[4:7]
    v_perm_b32 v160, v22, v22, v8
    v_perm_b32 v161, v22, v22, v9
    v_perm_b32 v162, v22, v22, v10
    v_perm_b32 v163, v22, v22, v11
    s_waitcnt vmcnt(25)
    s_nop 0
    v_mfma_f32_16x16x32_bf16 v[4:7], v[160:163], v[56:59], v[4:7]
    v_perm_b32 v164, v23, v23, v8
    v_perm_b32 v165, v23, v23, v9
    v_perm_b32 v166, v23, v23, v10
    v_perm_b32 v167, v23, v23, v11
    s_waitcnt vmcnt(24)
    s_nop 0
    v_mfma_f32_16x16x32_bf16 v[4:7], v[164:167], v[60:63], v[4:7]
    v_perm_b32 v160, v16, v16, v12
    v_perm_b32 v161, v16, v16, v13
    v_perm_b32 v162, v16, v16, v14
    v_perm_b32 v163, v16, v16, v15
    s_waitcnt vmcnt(23)
    s_nop 0
    v_mfma_f32_16x16x32_bf16 v[4:7], v[160:163], v[64:67], v[4:7]
    v_perm_b32 v164, v17, v17, v12
    v_perm_b32 v165, v17, v17, v13
    v_perm_b32 v166, v17, v17, v14
    v_perm_b32 v167, v17, v17, v15
    s_waitcnt vmcnt(22)
    s_nop 0
    v_mfma_f32_16x16x32_bf16 v[4:7], v[164:167], v[68:71], v[4:7]
    v_perm_b32 v160, v18, v18, v12
    v_perm_b32 v161, v18, v18, v13
    v_perm_b32 v162, v18, v18, v14
    v_perm_b32 v163, v18, v18, v15
    s_waitcnt vmcnt(21)
    s_nop 0
    v_mfma_f32_16x16x32_bf16 v[4:7], v[160:163], v[72:75], v[4:7]
    v_perm_b32 v164, v19, v19, v12
    v_perm_b32 v165, v19, v19, v13
    v_perm_b32 v166, v19, v19, v14
    v_perm_b32 v167, v19, v19, v15
    s_waitcnt vmcnt(20)
    s_nop 0
    v_mfma_f32_16x16x32_bf16 v[4:7], v[164:167], v[76:79], v[4:7]
    v_perm_b32 v160, v20, v20, v12
    v_perm_b32 v161, v20, v20, v13
    v_perm_b32 v162, v20, v20, v14
    v_perm_b32 v163, v20, v20, v15
    s_waitcnt vmcnt(19)
    s_nop 0
    v_mfma_f32_16x16x32_bf16 v[4:7], v[160:163], v[80:83], v[4:7]
    v_perm_b32 v164, v21, v21, v12
    v_perm_b32 v165, v21, v21, v13
    v_perm_b32 v166, v21, v21, v14
    v_perm_b32 v167, v21, v21, v15
    s_waitcnt vmcnt(18)
    s_nop 0
    v_mfma_f32_16x16x32_bf16 v[4:7], v[164:167], v[84:87], v[4:7]
    v_perm_b32 v160, v22, v22, v12
    v_perm_b32 v161, v22, v22, v13
    v_perm_b32 v162, v22, v22, v14
    v_perm_b32 v163, v22, v22, v15
    s_waitcnt vmcnt(17)
    s_nop 0
    v_mfma_f32_16x16x32_bf16 v[4:7], v[160:163], v[88:91], v[4:7]
    v_perm_b32 v164, v23, v23, v12
    v_perm_b32 v165, v23, v23, v13
    v_perm_b32 v166, v23, v23, v14
    v_perm_b32 v167, v23, v23, v15
    s_waitcnt vmcnt(16)
    s_nop 0
    v_mfma_f32_16x16x32_bf16 v[4:7], v[164:167], v[92:95], v[4:7]
    v_perm_b32 v160, v24, v24, v8
    v_perm_b32 v161, v24, v24, v9
    v_perm_b32 v162, v24, v24, v10
    v_perm_b32 v163, v24, v24, v11
    s_waitcnt vmcnt(15)
    s_nop 0
    v_mfma_f32_16x16x32_bf16 v[4:7], v[160:163], v[96:99], v[4:7]
    v_perm_b32 v164, v25, v25, v8
    v_perm_b32 v165, v25, v25, v9
    v_perm_b32 v166, v25, v25, v10
    v_perm_b32 v167, v25, v25, v11
    s_waitcnt vmcnt(14)
    s_nop 0
    v_mfma_f32_16x16x32_bf16 v[4:7], v[164:167], v[100:103], v[4:7]
    v_perm_b32 v160, v26, v26, v8
    v_perm_b32 v161, v26, v26, v9
    v_perm_b32 v162, v26, v26, v10
    v_perm_b32 v163, v26, v26, v11
    s_waitcnt vmcnt(13)
    s_nop 0
    v_mfma_f32_16x16x32_bf16 v[4:7], v[160:163], v[104:107], v[4:7]
    v_perm_b32 v164, v27, v27, v8
    v_perm_b32 v165, v27, v27, v9
    v_perm_b32 v166, v27, v27, v10
    v_perm_b32 v167, v27, v27, v11
    s_waitcnt vmcnt(12)
    s_nop 0
    v_mfma_f32_16x16x32_bf16 v[4:7], v[164:167], v[108:111], v[4:7]
    v_perm_b32 v160, v28, v28, v8
    v_perm_b32 v161, v28, v28, v9
    v_perm_b32 v162, v28, v28, v10
    v_perm_b32 v163, v28, v28, v11
    s_waitcnt vmcnt(11)
    s_nop 0
    v_mfma_f32_16x16x32_bf16 v[4:7], v[160:163], v[112:115], v[4:7]
    v_perm_b32 v164, v29, v29, v8
    v_perm_b32 v165, v29, v29, v9
    v_perm_b32 v166, v29, v29, v10
    v_perm_b32 v167, v29, v29, v11
    s_waitcnt vmcnt(10)
    s_nop 0
    v_mfma_f32_16x16x32_bf16 v[4:7], v[164:167], v[116:119], v[4:7]
    v_perm_b32 v160, v30, v30, v8
    v_perm_b32 v161, v30, v30, v9
    v_perm_b32 v162, v30, v30, v10
    v_perm_b32 v163, v30, v30, v11
    s_waitcnt vmcnt(9)
    s_nop 0
    v_mfma_f32_16x16x32_bf16 v[4:7], v[160:163], v[120:123], v[4:7]
    v_perm_b32 v164, v31, v31, v8
    v_perm_b32 v165, v31, v31, v9
    v_perm_b32 v166, v31, v31, v10
    v_perm_b32 v167, v31, v31, v11
    s_waitcnt vmcnt(8)
    s_nop 0
    v_mfma_f32_16x16x32_bf16 v[4:7], v[164:167], v[124:127], v[4:7]
    v_perm_b32 v160, v24, v24, v12
    v_perm_b32 v161, v24, v24, v13
    v_perm_b32 v162, v24, v24, v14
    v_perm_b32 v163, v24, v24, v15
    s_waitcnt vmcnt(7)
    s_nop 0
    v_mfma_f32_16x16x32_bf16 v[4:7], v[160:163], v[128:131], v[4:7]
    v_perm_b32 v164, v25, v25, v12
    v_perm_b32 v165, v25, v25, v13
    v_perm_b32 v166, v25, v25, v14
    v_perm_b32 v167, v25, v25, v15
    s_waitcnt vmcnt(6)
    s_nop 0
    v_mfma_f32_16x16x32_bf16 v[4:7], v[164:167], v[132:135], v[4:7]
    v_perm_b32 v160, v26, v26, v12
    v_perm_b32 v161, v26, v26, v13
    v_perm_b32 v162, v26, v26, v14
    v_perm_b32 v163, v26, v26, v15
    s_waitcnt vmcnt(5)
    s_nop 0
    v_mfma_f32_16x16x32_bf16 v[4:7], v[160:163], v[136:139], v[4:7]
    v_perm_b32 v164, v27, v27, v12
    v_perm_b32 v165, v27, v27, v13
    v_perm_b32 v166, v27, v27, v14
    v_perm_b32 v167, v27, v27, v15
    s_waitcnt vmcnt(4)
    s_nop 0
    v_mfma_f32_16x16x32_bf16 v[4:7], v[164:167], v[140:143], v[4:7]
    v_perm_b32 v160, v28, v28, v12
    v_perm_b32 v161, v28, v28, v13
    v_perm_b32 v162, v28, v28, v14
    v_perm_b32 v163, v28, v28, v15
    s_waitcnt vmcnt(3)
    s_nop 0
    v_mfma_f32_16x16x32_bf16 v[4:7], v[160:163], v[144:147], v[4:7]
    v_perm_b32 v164, v29, v29, v12
    v_perm_b32 v165, v29, v29, v13
    v_perm_b32 v166, v29, v29, v14
    v_perm_b32 v167, v29, v29, v15
    s_waitcnt vmcnt(2)
    s_nop 0
    v_mfma_f32_16x16x32_bf16 v[4:7], v[164:167], v[148:151], v[4:7]
    v_perm_b32 v160, v30, v30, v12
    v_perm_b32 v161, v30, v30, v13
    v_perm_b32 v162, v30, v30, v14
    v_perm_b32 v163, v30, v30, v15
    s_waitcnt vmcnt(1)
    s_nop 0
    v_mfma_f32_16x16x32_bf16 v[4:7], v[160:163], v[152:155], v[4:7]
    v_perm_b32 v164, v31, v31, v12
    v_perm_b32 v165, v31, v31, v13
    v_perm_b32 v166, v31, v31, v14
    v_perm_b32 v167, v31, v31, v15
    s_waitcnt vmcnt(0)
    s_nop 0
    v_mfma_f32_16x16x32_bf16 v[4:7], v[164:167], v[156:159], v[4:7]
    v_mov_b32 v1, 1
    s_mov_b32 exec_lo, 0x00ff00ff
    s_mov_b32 exec_hi, 0xff00ff00
    s_nop 4
    ds_write_b128 v3, v[4:7] offset:4096
    s_mov_b64 exec, 1
    ds_add_u32 v2, v1 offset:12
    s_mov_b64 exec, -1
    s_endpgm
L_D:
    s_setprio 1
    s_mov_b32 s13, 0
    s_mul_i32 s60, s4, 1280
    s_add_u32 s44, s16, s60
    s_addc_u32 s45, s17, 0
    s_mov_b32 s46, 1280
    s_mov_b32 s47, 0x20000
    s_mov_b32 s48, s34
    s_mov_b32 s49, s35
    s_mov_b32 s50, 1280
    s_mov_b32 s51, 0x20000
    v_lshlrev_b32 v3, 5, v0
    buffer_load_dwordx4 v[8:11], v3, s[44:47], 0 offen
    buffer_load_dwordx4 v[12:15], v3, s[44:47], 0 offen offset:16
    buffer_load_dwordx4 v[16:19], v3, s[48:51], 0 offen
    buffer_load_dwordx4 v[20:23], v3, s[48:51], 0 offen offset:16
    s_waitcnt vmcnt(0)
    v_mov_b32 v4, 0
    v_lshlrev_b32 v24, 16, v8
    v_and_b32 v25, 0xffff0000, v8
    v_lshlrev_b32 v26, 16, v16
    v_and_b32 v27, 0xffff0000, v16
    v_mul_f32 v24, v24, v26
    v_mul_f32 v25, v25, v27
    v_cvt_pk_bf16_f32 v24, v24, v25
    v_and_b32 v25, 0xffff0000, v24
    v_lshlrev_b32 v24, 16, v24
    v_add_f32 v4, v4, v24
    v_add_f32 v4, v4, v25
    v_lshlrev_b32 v24, 16, v9
    v_and_b32 v25, 0xffff0000, v9
    v_lshlrev_b32 v26, 16, v17
    v_and_b32 v27, 0xffff0000, v17
    v_mul_f32 v24, v24, v26
    v_mul_f32 v25, v25, v27
    v_cvt_pk_bf16_f32 v24, v24, v25
    v_and_b32 v25, 0xffff0000, v24
    v_lshlrev_b32 v24, 16, v24
    v_add_f32 v4, v4, v24
    v_add_f32 v4, v4, v25
    v_lshlrev_b32 v24, 16, v10
    v_and_b32 v25, 0xffff0000, v10
    v_lshlrev_b32 v26, 16, v18
    v_and_b32 v27, 0xffff0000, v18
    v_mul_f32 v24, v24, v26
    v_mul_f32 v25, v25, v27
    v_cvt_pk_bf16_f32 v24, v24, v25
    v_and_b32 v25, 0xffff0000, v24
    v_lshlrev_b32 v24, 16, v24
    v_add_f32 v4, v4, v24
    v_add_f32 v4, v4, v25
    v_lshlrev_b32 v24, 16, v11
    v_and_b32 v25, 0xffff0000, v11
    v_lshlrev_b32 v26, 16, v19
    v_and_b32 v27, 0xffff0000, v19
    v_mul_f32 v24, v24, v26
    v_mul_f32 v25, v25, v27
    v_cvt_pk_bf16_f32 v24, v24, v25
    v_and_b32 v25, 0xffff0000, v24
    v_lshlrev_b32 v24, 16, v24
    v_add_f32 v4, v4, v24
    v_add_f32 v4, v4, v25
    v_lshlrev_b32 v24, 16, v12
    v_and_b32 v25, 0xffff0000, v12
    v_lshlrev_b32 v26, 16, v20
    v_and_b32 v27, 0xffff0000, v20
    v_mul_f32 v24, v24, v26
    v_mul_f32 v25, v25, v27
    v_cvt_pk_bf16_f32 v24, v24, v25
    v_and_b32 v25, 0xffff0000, v24
    v_lshlrev_b32 v24, 16, v24
    v_add_f32 v4, v4, v24
    v_add_f32 v4, v4, v25
    v_lshlrev_b32 v24, 16, v13
    v_and_b32 v25, 0xffff0000, v13
    v_lshlrev_b32 v26, 16, v21
    v_and_b32 v27, 0xffff0000, v21
    v_mul_f32 v24, v24, v26
    v_mul_f32 v25, v25, v27
    v_cvt_pk_bf16_f32 v24, v24, v25
    v_and_b32 v25, 0xffff0000, v24
    v_lshlrev_b32 v24, 16, v24
    v_add_f32 v4, v4, v24
    v_add_f32 v4, v4, v25
    v_lshlrev_b32 v24, 16, v14
    v_and_b32 v25, 0xffff0000, v14
    v_lshlrev_b32 v26, 16, v22
    v_and_b32 v27, 0xffff0000, v22
    v_mul_f32 v24, v24, v26
    v_mul_f32 v25, v25, v27
    v_cvt_pk_bf16_f32 v24, v24, v25
    v_and_b32 v25, 0xffff0000, v24
    v_lshlrev_b32 v24, 16, v24
    v_add_f32 v4, v4, v24
    v_add_f32 v4, v4, v25
    v_lshlrev_b32 v24, 16, v15
    v_and_b32 v25, 0xffff0000, v15
    v_lshlrev_b32 v26, 16, v23
    v_and_b32 v27, 0xffff0000, v23
    v_mul_f32 v24, v24, v26
    v_mul_f32 v25, v25, v27
    v_cvt_pk_bf16_f32 v24, v24, v25
    v_and_b32 v25, 0xffff0000, v24
    v_lshlrev_b32 v24, 16, v24
    v_add_f32 v4, v4, v24
    v_add_f32 v4, v4, v25
    s_nop 1
    v_add_f32_dpp v4, v4, v4 row_ror:1 row_mask:0xf bank_mask:0xf
    s_nop 1
    v_add_f32_dpp v4, v4, v4 row_ror:2 row_mask:0xf bank_mask:0xf
    s_nop 1
    v_add_f32_dpp v4, v4, v4 row_ror:4 row_mask:0xf bank_mask:0xf
    s_nop 1
    v_add_f32_dpp v4, v4, v4 row_ror:8 row_mask:0xf bank_mask:0xf
    v_mov_b32 v5, v4
    s_nop 1
    v_permlane16_swap_b32 v4, v5
    v_add_f32 v4, v4, v5
    v_mov_b32 v5, v4
    s_nop 1
    v_permlane32_swap_b32 v4, v5
    v_add_f32 v4, v4, v5
    v_cvt_pk_bf16_f32 v4, v4, v4
    v_lshlrev_b32 v4, 16, v4
    v_mul_f32 v4, 0xbfb8aa3b, v4
    v_exp_f32 v4, v4
    s_nop 0
    v_add_f32 v4, 1.0, v4
    v_rcp_f32 v4, v4
    s_nop 0
    v_cvt_pk_bf16_f32 v4, v4, v4
    v_lshlrev_b32 v4, 16, v4
    v_sub_f32 v5, 1.0, v4
    v_cvt_pk_bf16_f32 v5, v5, v5
    v_lshlrev_b32 v5, 16, v5
    s_mov_b64 exec, 1
    ds_write_b64 v2, v[4:5] offset:40
    s_mov_b64 exec, -1
    s_branch L_nogate
L_ids2:
    v_and_b32 v3, 7, v0
    v_lshlrev_b32 v3, 3, v3
    s_mov_b32 s61, 0
    s_nop 0
L_xpoll:
    buffer_load_dwordx2 v[6:7], v3, s[52:55], s68 offen sc1
    s_waitcnt vmcnt(0)
    v_cmp_ne_u32 s[64:65], s11, v7
    s_nop 0
    s_cmp_eq_u64 s[64:65], 0
    s_nop 1
    s_cbranch_scc1 L_tagok_28
    s_add_u32 s61, s61, 1
    s_cmp_lt_u32 s61, 2097152
    s_cbranch_scc1 L_xpoll
    s_mov_b32 s62, 16
    s_branch L_fail
L_tagok_28:
    v_cmp_ne_u32 vcc, s14, v6
    s_nop 0
    s_cmp_eq_u64 vcc, 0
    s_cselect_b32 s60, 1, 2
    v_mov_b32 v4, s60
    s_mov_b64 exec, 1
    ds_write_b32 v2, v4 offset:48
    s_mov_b64 exec, -1
    s_setprio 1
L_nogate:
    s_add_u32 s14, s13, 4
    s_mul_i32 s14, s14, 2560
    s_cmp_lt_u32 s100, 27
    s_cbranch_scc1 L_Dwork
    v_mov_b32 v8, 0
    v_mov_b32 v9, 0
    v_mov_b32 v10, 0
    v_mov_b32 v11, 0
    v_lshlrev_b32 v4, 4, v0
    v_add_u32 v4, s14, v4
    ds_write_b128 v4, v[8:11] offset:6144
    ds_write_b128 v4, v[8:11] offset:7168
    s_mov_b32 exec_lo, 0xffffffff
    s_mov_b32 exec_hi, 0x0
    ds_write_b128 v4, v[8:11] offset:8192
    s_mov_b64 exec, -1
    v_mov_b32 v1, 1
    s_mov_b64 exec, 1
    ds_add_u32 v2, v1 offset:20
    s_mov_b64 exec, -1
    s_endpgm
L_Dwork:
    s_lshl_b32 s60, s101, 5
    s_lshl_b32 s61, s13, 4
    s_add_u32 s60, s60, s61
    s_mul_i32 s60, s60, 1280
    s_add_u32 s48, s32, s60
    s_addc_u32 s49, s33, 0
    s_mov_b32 s50, 20480
    s_mov_b32 s51, 0x20000
    s_mov_b32 s61, 0
L_spin_29:
    ds_read_b32 v1, v2 offset:28
    s_waitcnt lgkmcnt(0)
    v_readfirstlane_b32 s60, v1
    s_nop 0
    s_cmp_ge_u32 s60, 4
    s_nop 1
    s_cbranch_scc1 L_spind_30
    s_sleep 1
    s_add_u32 s61, s61, 1
    s_cmp_lt_u32 s61, 16777216
    s_cbranch_scc1 L_spin_29
    s_mov_b32 s62, 14
    s_branch L_fail
L_spind_30:
    v_lshrrev_b32 v3, 4, v0
    v_mul_u32_u24 v3, 5120, v3
    v_and_b32 v4, 15, v0
    v_lshl_add_u32 v3, v4, 4, v3
    s_movk_i32 s63, 3840
    buffer_load_dwordx4 v[32:35], v3, s[48:51], 0 offen offset:0 nt
    v_and_b32 v5, 1, v0
    buffer_load_dwordx4 v[36:39], v3, s[48:51], 0 offen offset:256 nt
    v_cmp_eq_u32 vcc, 1, v5
    buffer_load_dwordx4 v[40:43], v3, s[48:51], 0 offen offset:512 nt
    v_mov_b32 v6, 0x0c0c0100
    buffer_load_dwordx4 v[44:47], v3, s[48:51], 0 offen offset:768 nt
    v_mov_b32 v7, 0x01000c0c
    buffer_load_dwordx4 v[48:51], v3, s[48:51], 0 offen offset:1024 nt
    v_cndmask_b32 v6, v6, v7, vcc
    buffer_load_dwordx4 v[52:55], v3, s[48:51], 0 offen offset:1280 nt
    v_mov_b32 v5, 0x0c0c0302
    buffer_load_dwordx4 v[56:59], v3, s[48:51], 0 offen offset:1536 nt
    v_mov_b32 v7, 0x03020c0c
    buffer_load_dwordx4 v[60:63], v3, s[48:51], 0 offen offset:1792 nt
    v_cndmask_b32 v7, v5, v7, vcc
    buffer_load_dwordx4 v[64:67], v3, s[48:51], 0 offen offset:2048 nt
    v_bfe_u32 v5, v0, 1, 2
    buffer_load_dwordx4 v[68:71], v3, s[48:51], 0 offen offset:2304 nt
    v_cmp_eq_u32 vcc, 0, v5
    buffer_load_dwordx4 v[72:75], v3, s[48:51], 0 offen offset:2560 nt
    v_mov_b32 v8, 0x0c0c0c0c
    buffer_load_dwordx4 v[76:79], v3, s[48:51], 0 offen offset:2816 nt
    v_mov_b32 v12, 0x0c0c0c0c
    buffer_load_dwordx4 v[80:83], v3, s[48:51], 0 offen offset:3072 nt
    v_cndmask_b32 v8, v8, v6, vcc
    buffer_load_dwordx4 v[84:87], v3, s[48:51], 0 offen offset:3328 nt
    v_cndmask_b32 v12, v12, v7, vcc
    buffer_load_dwordx4 v[88:91], v3, s[48:51], 0 offen offset:3584 nt
    v_cmp_eq_u32 vcc, 1, v5
    s_setprio 0
    buffer_load_dwordx4 v[92:95], v3, s[48:51], s63 offen offset:0 nt
    v_mov_b32 v9, 0x0c0c0c0c
    buffer_load_dwordx4 v[96:99], v3, s[48:51], s63 offen offset:256 nt
    v_mov_b32 v13, 0x0c0c0c0c
    buffer_load_dwordx4 v[100:103], v3, s[48:51], s63 offen offset:512 nt
    v_cndmask_b32 v9, v9, v6, vcc
    buffer_load_dwordx4 v[104:107], v3, s[48:51], s63 offen offset:768 nt
    v_cndmask_b32 v13, v13, v7, vcc
    buffer_load_dwordx4 v[108:111], v3, s[48:51], s63 offen offset:1024 nt
    v_cmp_eq_u32 vcc, 2, v5
    v_mov_b32 v10, 0x0c0c0c0c
    v_mov_b32 v14, 0x0c0c0c0c
    v_cndmask_b32 v10, v10, v6, vcc
    v_cndmask_b32 v14, v14, v7, vcc
    v_cmp_eq_u32 vcc, 3, v5
    v_mov_b32 v11, 0x0c0c0c0c
    v_mov_b32 v15, 0x0c0c0c0c
    v_cndmask_b32 v11, v11, v6, vcc
    v_cndmask_b32 v15, v15, v7, vcc
    s_setprio 3
    v_and_b32 v4, 15, v0
    v_lshlrev_b32 v4, 5, v4
    v_lshrrev_b32 v6, 4, v0
    v_lshl_add_u32 v4, v6, 4, v4
    v_add_u32 v4, s14, v4
    v_lshrrev_b32 v5, 4, v0
    v_lshlrev_b32 v5, 3, v5
    s_lshl_b32 s60, s13, 5
    v_add_u32 v5, s60, v5
    s_mov_b32 s61, 0
    s_nop 0
L_spin_31:
    ds_read_b32 v1, v2 offset:16
    s_waitcnt lgkmcnt(0)
    v_readfirstlane_b32 s60, v1
    s_nop 0
    s_cmp_ge_u32 s60, 1
    s_nop 1
    s_cbranch_scc1 L_spind_32
    s_sleep 1
    s_add_u32 s61, s61, 1
    s_cmp_lt_u32 s61, 16777216
    s_cbranch_scc1 L_spin_31
    s_mov_b32 s62, 11
    s_branch L_fail
L_spind_32:
    ds_read_b64 v[24:25], v5 offset:512
    s_waitcnt lgkmcnt(0)
    v_perm_b32 v16, v24, v24, v8
    v_perm_b32 v17, v24, v24, v9
    v_perm_b32 v18, v24, v24, v10
    v_perm_b32 v19, v24, v24, v11
    s_waitcnt vmcnt(19)
    s_nop 0
    v_mfma_f32_16x16x32_bf16 v[112:115], v[16:19], v[32:35], 0
    s_waitcnt vmcnt(18)
    v_mfma_f32_16x16x32_bf16 v[116:119], v[16:19], v[36:39], 0
    s_waitcnt vmcnt(17)
    v_mfma_f32_16x16x32_bf16 v[120:123], v[16:19], v[40:43], 0
    s_waitcnt vmcnt(16)
    v_mfma_f32_16x16x32_bf16 v[124:127], v[16:19], v[44:47], 0
    s_waitcnt vmcnt(15)
    v_mfma_f32_16x16x32_bf16 v[128:131], v[16:19], v[48:51], 0
    v_perm_b32 v20, v24, v24, v12
    v_perm_b32 v21, v24, v24, v13
    v_perm_b32 v22, v24, v24, v14
    v_perm_b32 v23, v24, v24, v15
    s_waitcnt vmcnt(14)
    s_nop 0
    v_mfma_f32_16x16x32_bf16 v[112:115], v[20:23], v[52:55], v[112:115]
    s_waitcnt vmcnt(13)
    v_mfma_f32_16x16x32_bf16 v[116:119], v[20:23], v[56:59], v[116:119]
    s_waitcnt vmcnt(12)
    v_mfma_f32_16x16x32_bf16 v[120:123], v[20:23], v[60:63], v[120:123]
    s_waitcnt vmcnt(11)
    v_mfma_f32_16x16x32_bf16 v[124:127], v[20:23], v[64:67], v[124:127]
    s_waitcnt vmcnt(10)
    v_mfma_f32_16x16x32_bf16 v[128:131], v[20:23], v[68:71], v[128:131]
    v_perm_b32 v16, v25, v25, v8
    v_perm_b32 v17, v25, v25, v9
    v_perm_b32 v18, v25, v25, v10
    v_perm_b32 v19, v25, v25, v11
    s_waitcnt vmcnt(9)
    s_nop 0
    v_mfma_f32_16x16x32_bf16 v[112:115], v[16:19], v[72:75], v[112:115]
    s_waitcnt vmcnt(8)
    v_mfma_f32_16x16x32_bf16 v[116:119], v[16:19], v[76:79], v[116:119]
    s_waitcnt vmcnt(7)
    v_mfma_f32_16x16x32_bf16 v[120:123], v[16:19], v[80:83], v[120:123]
    s_waitcnt vmcnt(6)
    v_mfma_f32_16x16x32_bf16 v[124:127], v[16:19], v[84:87], v[124:127]
    s_waitcnt vmcnt(5)
    v_mfma_f32_16x16x32_bf16 v[128:131], v[16:19], v[88:91], v[128:131]
    v_perm_b32 v20, v25, v25, v12
    v_perm_b32 v21, v25, v25, v13
    v_perm_b32 v22, v25, v25, v14
    v_perm_b32 v23, v25, v25, v15
    s_waitcnt vmcnt(4)
    s_nop 0
    v_mfma_f32_16x16x32_bf16 v[112:115], v[20:23], v[92:95], v[112:115]
    s_waitcnt vmcnt(3)
    v_mfma_f32_16x16x32_bf16 v[116:119], v[20:23], v[96:99], v[116:119]
    s_waitcnt vmcnt(2)
    v_mfma_f32_16x16x32_bf16 v[120:123], v[20:23], v[100:103], v[120:123]
    s_waitcnt vmcnt(1)
    v_mfma_f32_16x16x32_bf16 v[124:127], v[20:23], v[104:107], v[124:127]
    s_waitcnt vmcnt(0)
    v_mfma_f32_16x16x32_bf16 v[128:131], v[20:23], v[108:111], v[128:131]
    s_mov_b32 exec_lo, 0xffffffff
    s_mov_b32 exec_hi, 0x0
    ds_write_b128 v4, v[112:115] offset:6144
    ds_write_b128 v4, v[116:119] offset:6656
    ds_write_b128 v4, v[120:123] offset:7168
    s_nop 0
    ds_write_b128 v4, v[124:127] offset:7680
    s_nop 0
    ds_write_b128 v4, v[128:131] offset:8192
    s_mov_b64 exec, -1
    v_mov_b32 v1, 1
    s_mov_b64 exec, 1
    ds_add_u32 v2, v1 offset:20
    s_mov_b64 exec, -1
    s_endpgm
L_fail:
    s_mov_b32 s44, s38
    s_mov_b32 s45, s39
    s_mov_b32 s46, 256
    s_mov_b32 s47, 0x20000
    s_lshl_b32 s60, s62, 2
    v_mov_b32 v1, 1
    s_mov_b64 exec, 1
    buffer_atomic_add v1, v2, s[44:47], s60 offen
L_exit:
    s_endpgm
L_codeend:
.section .rodata,"a"
.p2align 6
.amdhsa_kernel gated_mix__sliding_block_cached__glu_gated_geglu__decode_kernel
  .amdhsa_next_free_vgpr 168
  .amdhsa_next_free_sgpr 102
  .amdhsa_accum_offset 168
  .amdhsa_group_segment_fixed_size 0
  .amdhsa_kernarg_size 104
  .amdhsa_user_sgpr_count 2
  .amdhsa_user_sgpr_kernarg_segment_ptr 1
  .amdhsa_system_sgpr_workgroup_id_x 1
  .amdhsa_float_denorm_mode_32 3
.end_amdhsa_kernel
```
